```python
import torch

def _softmax(x, axis=-1):
    return torch.softmax(x, dim=axis)
def _gelu(x):
    return torch.nn.functional.gelu(x, approximate="tanh")
def _silu(x):
    return torch.nn.functional.silu(x)
def _sigmoid(x):
    return torch.sigmoid(x)
def _layernorm(x, axis=-1, eps=1e-5):
    m = x.mean(dim=axis, keepdim=True)
    v = x.var(dim=axis, keepdim=True, unbiased=False)
    return (x - m) / torch.sqrt(v + eps)
def _scatter_add(tgt, idx, src, axis=0):
    return tgt.clone().index_add_(axis, idx, src)
def _segment_sum(src, seg, n):
    out = torch.zeros((n,) + src.shape[1:], dtype=src.dtype)
    return out.index_add_(0, seg, src)
def _pad(x, pw):
    flat = tuple(v for pair in reversed(pw) for v in pair)
    return torch.nn.functional.pad(x, flat)

kernel_name = 'sequential_preLN__compressed_kv_cla__swiglu_ffn__decode'

def setup_inputs():

    _w = (lambda a: (lambda t: t.to(torch.bfloat16) if t.is_floating_point() else t)(torch.as_tensor(a)))
    def _A_setup():
        B, H, Sq, Sk, D, M = 4, 32, 1, 4096, 128, 512
        Dc = 4 * D
        return {
            "x": _w((lambda *s: torch.randn(*s, dtype=torch.bfloat16) * 0.05)(B, Sq, M)),
            "c_kv": _w((lambda *s: torch.randn(*s, dtype=torch.bfloat16) * 0.4)(B, Sk, Dc)),
            "w_q": _w((lambda *s: torch.randn(*s, dtype=torch.bfloat16) * 3.2)(M, H, D) * (M ** -0.5)),
            "w_uk": _w((lambda *s: torch.randn(*s, dtype=torch.bfloat16) * 3.2)(Dc, H, D) * (Dc ** -0.5)),
            "w_uv": _w((lambda *s: torch.randn(*s, dtype=torch.bfloat16) * 0.4)(Dc, H, D) * (Dc ** -0.5)),
            "w_o": _w((lambda *s: torch.randn(*s, dtype=torch.bfloat16) * 0.4)(H, D, M) * ((H * D) ** -0.5)),
        }
    _A_in = _A_setup()

    def _B_setup():
        B, S, D, F = 4, 1, 512, 1792
        return {
            "x": _w((lambda *s: torch.randn(*s, dtype=torch.bfloat16) * 0.05)(B, S, D)),
            "w_gate": _w((lambda *s: torch.randn(*s, dtype=torch.bfloat16) * 0.05)(D, F)),
            "w_up": _w((lambda *s: torch.randn(*s, dtype=torch.bfloat16) * 0.05)(D, F)),
            "w_down": _w((lambda *s: torch.randn(*s, dtype=torch.bfloat16) * 0.05)(F, D)),
        }
    _B_in = _B_setup()

    return {
        "A_x": _A_in["x"],
        "A_c_kv": _A_in["c_kv"],
        "A_w_q": _A_in["w_q"],
        "A_w_uk": _A_in["w_uk"],
        "A_w_uv": _A_in["w_uv"],
        "A_w_o": _A_in["w_o"],
        "B_x": _B_in["x"],
        "B_w_gate": _B_in["w_gate"],
        "B_w_up": _B_in["w_up"],
        "B_w_down": _B_in["w_down"],
    }

def reference(A_x, A_c_kv, A_w_q, A_w_uk, A_w_uv, A_w_o, B_x, B_w_gate, B_w_up, B_w_down):
    def _A_ref(x, c_kv, w_q, w_uk, w_uv, w_o):
        B, Sq, M = x.shape[0], x.shape[1], x.shape[2]
        Sk = c_kv.shape[1]
        H, D = w_q.shape[1], w_q.shape[2]
        q = torch.einsum("bqm,mhd->bhqd", x, w_q)
        k = torch.einsum("bkc,chd->bhkd", c_kv, w_uk)
        v = torch.einsum("bkc,chd->bhkd", c_kv, w_uv)
        scores = torch.einsum("bhqd,bhkd->bhqk", q, k) * (D ** -0.5)
        off = Sk - Sq
        qi = torch.arange(Sq)[:, None]
        kj = torch.arange(Sk)[None, :]
        cmask = kj <= (qi + off)
        scores = torch.where(cmask[None, None], scores, -1e9)
        p = _softmax(scores, axis=-1)
        ctx = torch.einsum("bhqk,bhkd->bhqd", p, v)
        return torch.einsum("bhqd,hdm->bqm", ctx, w_o)

    def _B_ref(x, w_gate, w_up, w_down):
        g = _silu(x @ w_gate)
        u = x @ w_up
        return (g * u) @ w_down

    x = A_x
    h = x + _A_ref(_layernorm(x, axis=-1), A_c_kv, A_w_q, A_w_uk, A_w_uv, A_w_o)
    h2 = h + _B_ref(_layernorm(h, axis=-1), B_w_gate, B_w_up, B_w_down)
    return h2
```

```asm
; @launch grid=(256,1,1) block=(512,1,1) lds=163840
    .amdgcn_target "amdgcn-amd-amdhsa--gfx950"
    .text
    .globl sequential_preLN__compressed_kv_cla__swiglu_ffn__decode_kernel
    .p2align 8
    .type sequential_preLN__compressed_kv_cla__swiglu_ffn__decode_kernel,@function
sequential_preLN__compressed_kv_cla__swiglu_ffn__decode_kernel:
    s_cmp_ge_u32 s2, 256
    s_cbranch_scc1 L_END
    s_load_dwordx16 s[4:19], s[0:1], 0
    s_load_dwordx8 s[20:27], s[0:1], 64
    s_load_dwordx2 s[28:29], s[0:1], 96
    v_lshrrev_b32 v1, 6, v0
    v_and_b32 v0, 63, v0
    v_readfirstlane_b32 s3, v1
    s_mov_b32 s31, 0
    s_cmp_lg_u32 s3, 7
    s_cbranch_scc1 L_NOPF
    s_getpc_b64 s[48:49]
L_PCREF:
    s_sub_u32 s48, s48, L_PCREF-sequential_preLN__compressed_kv_cla__swiglu_ffn__decode_kernel
    s_subb_u32 s49, s49, 0
    s_and_b32 s49, s49, 0xffff
    s_mov_b32 s50, L_CODE_END-sequential_preLN__compressed_kv_cla__swiglu_ffn__decode_kernel
    s_mov_b32 s51, 0x20000
    s_lshr_b32 s52, s2, 3
    s_lshl_b32 s52, s52, 10
    v_lshlrev_b32 v1, 4, v0
    buffer_load_dwordx4 v[252:255], v1, s[48:51], s52 offen
L_NOPF:
    s_waitcnt lgkmcnt(0)
    s_load_dword s30, s[28:29], 0
    s_mov_b32 s32, s28
    s_and_b32 s33, s29, 0xffff
    s_mov_b32 s34, 0x900000
    s_mov_b32 s35, 0x20000
    s_cmp_lt_u32 s2, 128
    s_cbranch_scc1 L_X
L_Y:
    s_getreg_b32 s63, hwreg(HW_REG_XCC_ID)
    s_sub_u32 s56, s2, 128
    s_and_b32 s52, s56, 7
    s_lshr_b32 s53, s56, 3
    s_lshr_b32 s57, s53, 2
    s_xor_b32 s57, s57, 2
    s_lshl_b32 s54, s52, 2
    s_add_u32 s54, s54, s57
    s_and_b32 s55, s53, 3

    v_and_b32 v1, 15, v0
    v_lshrrev_b32 v2, 4, v0
    s_cmp_ge_u32 s3, 4
    s_cbranch_scc1 L_Y_UK
    s_mov_b32 s36, s4
    s_and_b32 s37, s5, 0xffff
    s_mov_b32 s38, 0x1000
    s_mov_b32 s39, 0x20000
    s_mov_b32 s40, s8
    s_and_b32 s41, s9, 0xffff
    s_mov_b32 s42, 0x400000
    s_mov_b32 s43, 0x20000
    s_cmp_lg_u32 s3, 0
    s_cbranch_scc1 L_Y_NOCLR
    v_mov_b32 v72, -1
    v_mov_b32 v73, -1
    v_mov_b32 v74, -1
    v_mov_b32 v75, -1
    v_lshlrev_b32 v4, 15, v2
    v_lshl_add_u32 v4, v1, 4, v4
    s_lshl_b32 s57, s54, 10
    s_lshl_b32 s58, s55, 8
    s_add_u32 s57, s57, s58
    s_add_u32 s57, s57, 0x100000
    buffer_store_dwordx4 v[72:75], v4, s[32:35], s57 offen sc1
L_Y_NOCLR:
    v_lshlrev_b32 v3, 4, v0
    s_lshl_b32 s56, s3, 10
    buffer_load_dwordx4 v[4:7], v3, s[36:39], s56 offen

    v_lshlrev_b32 v3, 16, v2
    v_lshl_add_u32 v3, v1, 4, v3
    s_lshl_b32 s56, s55, 7
    s_lshl_b32 s57, s3, 5
    s_add_u32 s56, s56, s57
    s_lshl_b32 s58, s56, 13
    s_lshl_b32 s57, s54, 8
    s_add_u32 s58, s58, s57
    buffer_load_dwordx4 v[32:35], v3, s[40:43], s58 offen nt
    s_add_u32 s58, s58, 8192
    buffer_load_dwordx4 v[36:39], v3, s[40:43], s58 offen nt
    s_add_u32 s58, s58, 8192
    buffer_load_dwordx4 v[40:43], v3, s[40:43], s58 offen nt
    s_add_u32 s58, s58, 8192
    buffer_load_dwordx4 v[44:47], v3, s[40:43], s58 offen nt
    s_add_u32 s58, s58, 8192
    buffer_load_dwordx4 v[48:51], v3, s[40:43], s58 offen nt
    s_add_u32 s58, s58, 8192
    buffer_load_dwordx4 v[52:55], v3, s[40:43], s58 offen nt
    s_add_u32 s58, s58, 8192
    buffer_load_dwordx4 v[56:59], v3, s[40:43], s58 offen nt
    s_add_u32 s58, s58, 8192
    buffer_load_dwordx4 v[60:63], v3, s[40:43], s58 offen nt
    s_waitcnt vmcnt(8)
    v_lshlrev_b32 v8, 16, v4
    v_and_b32 v9, 0xffff0000, v4
    v_lshlrev_b32 v10, 16, v5
    v_and_b32 v11, 0xffff0000, v5
    v_lshlrev_b32 v12, 16, v6
    v_and_b32 v13, 0xffff0000, v6
    v_lshlrev_b32 v14, 16, v7
    v_and_b32 v15, 0xffff0000, v7
    v_add_f32 v16, v8, v9
    v_add_f32 v17, v10, v11
    v_add_f32 v18, v12, v13
    v_add_f32 v19, v14, v15
    v_add_f32 v16, v16, v17
    v_add_f32 v18, v18, v19
    v_add_f32 v16, v16, v18
    s_nop 1
    v_add_f32_dpp v16, v16, v16 row_shr:1 row_mask:0xf bank_mask:0xf bound_ctrl:0
    s_nop 1
    v_add_f32_dpp v16, v16, v16 row_shr:2 row_mask:0xf bank_mask:0xf bound_ctrl:0
    s_nop 1
    v_add_f32_dpp v16, v16, v16 row_shr:4 row_mask:0xf bank_mask:0xf bound_ctrl:0
    s_nop 1
    v_add_f32_dpp v16, v16, v16 row_shr:8 row_mask:0xf bank_mask:0xf bound_ctrl:0
    s_nop 1
    v_add_f32_dpp v16, v16, v16 row_bcast:15 row_mask:0xa bank_mask:0xf
    s_nop 1
    v_add_f32_dpp v16, v16, v16 row_bcast:31 row_mask:0xc bank_mask:0xf
    s_nop 0
    v_readlane_b32 s57, v16, 63
    s_nop 1
    v_mov_b32 v16, 0x3b000000
    v_mul_f32 v16, s57, v16
    v_sub_f32 v20, v8, v16
    v_sub_f32 v21, v9, v16
    v_sub_f32 v22, v10, v16
    v_sub_f32 v23, v11, v16
    v_sub_f32 v24, v12, v16
    v_sub_f32 v25, v13, v16
    v_sub_f32 v26, v14, v16
    v_sub_f32 v27, v15, v16
    v_mul_f32 v17, v20, v20
    v_fmac_f32 v17, v21, v21
    v_fmac_f32 v17, v22, v22
    v_fmac_f32 v17, v23, v23
    v_fmac_f32 v17, v24, v24
    v_fmac_f32 v17, v25, v25
    v_fmac_f32 v17, v26, v26
    v_fmac_f32 v17, v27, v27
    s_nop 1
    v_add_f32_dpp v17, v17, v17 row_shr:1 row_mask:0xf bank_mask:0xf bound_ctrl:0
    s_nop 1
    v_add_f32_dpp v17, v17, v17 row_shr:2 row_mask:0xf bank_mask:0xf bound_ctrl:0
    s_nop 1
    v_add_f32_dpp v17, v17, v17 row_shr:4 row_mask:0xf bank_mask:0xf bound_ctrl:0
    s_nop 1
    v_add_f32_dpp v17, v17, v17 row_shr:8 row_mask:0xf bank_mask:0xf bound_ctrl:0
    s_nop 1
    v_add_f32_dpp v17, v17, v17 row_bcast:15 row_mask:0xa bank_mask:0xf
    s_nop 1
    v_add_f32_dpp v17, v17, v17 row_bcast:31 row_mask:0xc bank_mask:0xf
    s_nop 0
    v_readlane_b32 s57, v17, 63
    s_nop 1
    v_mov_b32 v17, 0x3b000000
    v_mul_f32 v17, s57, v17
    v_cvt_pk_bf16_f32 v16, v16, v16
    v_and_b32 v16, 0xffff0000, v16
    v_cvt_pk_bf16_f32 v17, v17, v17
    v_and_b32 v17, 0xffff0000, v17
    v_add_f32 v17, 0x3727c5ac, v17
    v_cvt_pk_bf16_f32 v17, v17, v17
    v_and_b32 v17, 0xffff0000, v17
    v_sqrt_f32 v17, v17
    s_nop 0
    v_cvt_pk_bf16_f32 v17, v17, v17
    v_and_b32 v17, 0xffff0000, v17
    v_rcp_f32 v17, v17
    v_sub_f32 v20, v8, v16
    v_sub_f32 v21, v9, v16
    v_sub_f32 v22, v10, v16
    v_sub_f32 v23, v11, v16
    v_sub_f32 v24, v12, v16
    v_sub_f32 v25, v13, v16
    v_sub_f32 v26, v14, v16
    v_sub_f32 v27, v15, v16
    v_cvt_pk_bf16_f32 v20, v20, v20
    v_and_b32 v20, 0xffff0000, v20
    v_cvt_pk_bf16_f32 v21, v21, v21
    v_and_b32 v21, 0xffff0000, v21
    v_cvt_pk_bf16_f32 v22, v22, v22
    v_and_b32 v22, 0xffff0000, v22
    v_cvt_pk_bf16_f32 v23, v23, v23
    v_and_b32 v23, 0xffff0000, v23
    v_cvt_pk_bf16_f32 v24, v24, v24
    v_and_b32 v24, 0xffff0000, v24
    v_cvt_pk_bf16_f32 v25, v25, v25
    v_and_b32 v25, 0xffff0000, v25
    v_cvt_pk_bf16_f32 v26, v26, v26
    v_and_b32 v26, 0xffff0000, v26
    v_cvt_pk_bf16_f32 v27, v27, v27
    v_and_b32 v27, 0xffff0000, v27
    v_mul_f32 v20, v20, v17
    v_mul_f32 v21, v21, v17
    v_mul_f32 v22, v22, v17
    v_mul_f32 v23, v23, v17
    v_mul_f32 v24, v24, v17
    v_mul_f32 v25, v25, v17
    v_mul_f32 v26, v26, v17
    v_mul_f32 v27, v27, v17
    v_cvt_pk_bf16_f32 v20, v20, v20
    v_cvt_pk_bf16_f32 v21, v21, v21
    v_cvt_pk_bf16_f32 v22, v22, v22
    v_cvt_pk_bf16_f32 v23, v23, v23
    v_cvt_pk_bf16_f32 v24, v24, v24
    v_cvt_pk_bf16_f32 v25, v25, v25
    v_cvt_pk_bf16_f32 v26, v26, v26
    v_cvt_pk_bf16_f32 v27, v27, v27
    s_lshl_b32 s57, s3, 11
    v_lshlrev_b32 v3, 5, v0
    v_add_u32 v3, s57, v3
    ds_write_b128 v3, v[20:23] offset:0
    ds_write_b128 v3, v[24:27] offset:16
    v_and_b32 v4, 3, v1
    v_mov_b32 v5, 0xffff
    v_mov_b32 v6, 0xffff0000
    v_and_b32 v7, 1, v1
    v_cmp_eq_u32 vcc, 1, v7
    s_nop 1
    v_cndmask_b32 v5, v5, v6, vcc
    v_cmp_gt_u32 vcc, 2, v4
    s_nop 1
    v_cndmask_b32 v8, 0, v5, vcc
    v_cndmask_b32 v9, v5, 0, vcc
    v_lshrrev_b32 v3, 2, v1
    v_lshlrev_b32 v3, 11, v3
    v_lshl_add_u32 v3, v2, 5, v3
    s_lshl_b32 s57, s56, 2
    v_add_u32 v3, s57, v3
    s_waitcnt lgkmcnt(0)
    s_barrier
    ds_read_b128 v[16:19], v3 offset:0
    ds_read_b128 v[20:23], v3 offset:16
    s_add_u32 s30, s30, 0x9e3779b1
    s_and_b32 s60, s2, 7
    s_lshl_b32 s60, s60, 5
    s_lshr_b32 s61, s2, 3
    s_add_u32 s60, s60, s61
    s_lshl_b32 s60, s60, 4
    s_add_u32 s60, s60, 0x1000
    v_mov_b32 v68, s63
    v_mov_b32 v69, s30
    v_mov_b32 v70, s63
    v_mov_b32 v71, s30
    v_mov_b32 v72, 0
    s_cmp_eq_u32 s3, 0
    s_cselect_b32 s60, s60, 0x900000
    s_mov_b64 exec, 1
    buffer_store_dwordx4 v[68:71], v72, s[32:35], s60 offen sc1
    s_mov_b64 exec, -1
    s_waitcnt lgkmcnt(0)
    v_and_b32 v10, v16, v8
    v_and_b32 v11, v16, v9
    s_waitcnt vmcnt(8)
    s_nop 0
    v_mfma_f32_16x16x16_bf16 v[24:27], v[10:11], v[32:33], 0
    v_mfma_f32_16x16x16_bf16 v[28:31], v[10:11], v[34:35], 0
    v_and_b32 v12, v17, v8
    v_and_b32 v13, v17, v9
    s_waitcnt vmcnt(7)
    s_nop 0
    v_mfma_f32_16x16x16_bf16 v[24:27], v[12:13], v[36:37], v[24:27]
    v_mfma_f32_16x16x16_bf16 v[28:31], v[12:13], v[38:39], v[28:31]
    v_and_b32 v10, v18, v8
    v_and_b32 v11, v18, v9
    s_waitcnt vmcnt(6)
    s_nop 0
    v_mfma_f32_16x16x16_bf16 v[24:27], v[10:11], v[40:41], v[24:27]
    v_mfma_f32_16x16x16_bf16 v[28:31], v[10:11], v[42:43], v[28:31]
    v_and_b32 v12, v19, v8
    v_and_b32 v13, v19, v9
    s_waitcnt vmcnt(5)
    s_nop 0
    v_mfma_f32_16x16x16_bf16 v[24:27], v[12:13], v[44:45], v[24:27]
    v_mfma_f32_16x16x16_bf16 v[28:31], v[12:13], v[46:47], v[28:31]
    v_and_b32 v10, v20, v8
    v_and_b32 v11, v20, v9
    s_waitcnt vmcnt(4)
    s_nop 0
    v_mfma_f32_16x16x16_bf16 v[24:27], v[10:11], v[48:49], v[24:27]
    v_mfma_f32_16x16x16_bf16 v[28:31], v[10:11], v[50:51], v[28:31]
    v_and_b32 v12, v21, v8
    v_and_b32 v13, v21, v9
    s_waitcnt vmcnt(3)
    s_nop 0
    v_mfma_f32_16x16x16_bf16 v[24:27], v[12:13], v[52:53], v[24:27]
    v_mfma_f32_16x16x16_bf16 v[28:31], v[12:13], v[54:55], v[28:31]
    v_and_b32 v10, v22, v8
    v_and_b32 v11, v22, v9
    s_waitcnt vmcnt(2)
    s_nop 0
    v_mfma_f32_16x16x16_bf16 v[24:27], v[10:11], v[56:57], v[24:27]
    v_mfma_f32_16x16x16_bf16 v[28:31], v[10:11], v[58:59], v[28:31]
    v_and_b32 v12, v23, v8
    v_and_b32 v13, v23, v9
    s_waitcnt vmcnt(1)
    s_nop 0
    v_mfma_f32_16x16x16_bf16 v[24:27], v[12:13], v[60:61], v[24:27]
    v_mfma_f32_16x16x16_bf16 v[28:31], v[12:13], v[62:63], v[28:31]
    s_lshl_b32 s57, s3, 11
    v_lshlrev_b32 v3, 9, v2
    v_lshl_add_u32 v3, v1, 5, v3
    v_add_u32 v3, s57, v3
    s_nop 4
    ds_write_b128 v3, v[24:27] offset:8192
    ds_write_b128 v3, v[28:31] offset:8208
    s_lshl_b32 s57, s3, 6
    v_add_u32 v4, s57, v0
    v_lshlrev_b32 v5, 3, v4
    v_lshlrev_b32 v6, 4, v4
    s_waitcnt lgkmcnt(0)
    s_barrier
    ds_read_b64 v[8:9], v5 offset:8192
    ds_read_b64 v[10:11], v5 offset:10240
    ds_read_b64 v[12:13], v5 offset:12288
    ds_read_b64 v[14:15], v5 offset:14336
    s_lshl_b32 s56, s54, 14
    s_add_u32 s56, s56, 0x80000
    s_lshl_b32 s57, s55, 12
    s_add_u32 s57, s57, s56
    s_add_u32 s58, s56, 4096
    s_add_u32 s59, s56, 8192
    s_add_u32 s60, s56, 12288
    s_waitcnt lgkmcnt(0)
    v_add_f32 v8, v8, v10
    v_add_f32 v12, v12, v14
    v_add_f32 v9, v9, v11
    v_add_f32 v13, v13, v15
    v_add_f32 v16, v8, v12
    v_add_f32 v18, v9, v13
    v_mov_b32 v17, s30
    v_mov_b32 v19, s30
    v_add_u32 v7, 0x780000, v6
    buffer_store_dwordx4 v[16:19], v7, s[32:35], s57 offen
    v_mov_b32 v20, v7
L_QPOLL_18:
    buffer_load_dwordx4 v[32:35], v20, s[32:35], s56 offen sc1
    buffer_load_dwordx4 v[36:39], v20, s[32:35], s58 offen sc1
    buffer_load_dwordx4 v[40:43], v20, s[32:35], s59 offen sc1
    buffer_load_dwordx4 v[44:47], v20, s[32:35], s60 offen sc1
    s_waitcnt vmcnt(0)
    v_cmpx_eq_u32 vcc, s30, v33
    v_cmpx_eq_u32 vcc, s30, v35
    v_cmpx_eq_u32 vcc, s30, v37
    v_cmpx_eq_u32 vcc, s30, v39
    v_cmpx_eq_u32 vcc, s30, v41
    v_cmpx_eq_u32 vcc, s30, v43
    v_cmpx_eq_u32 vcc, s30, v45
    v_cmpx_eq_u32 vcc, s30, v47
    s_cmp_eq_u64 exec, -1
    s_mov_b64 exec, -1
    s_cbranch_scc1 L_QOK_19
    s_and_b32 s61, s31, 127
    s_cmp_eq_u32 s61, 127
    s_cselect_b32 s61, 0, 0x780000
    v_add_u32 v20, s61, v6
    s_cbranch_scc0 L_Y_NOGP
    buffer_store_dwordx4 v[16:19], v6, s[32:35], s57 offen sc1
L_Y_NOGP:
    s_add_u32 s31, s31, 1
    s_cmp_lt_u32 s31, 100000
    s_cbranch_scc1 L_QPOLL_18
    s_branch L_BAIL
L_QOK_19:
    buffer_store_dwordx4 v[16:19], v6, s[32:35], s57 offen sc1
    v_add_f32 v32, v32, v36
    v_add_f32 v40, v40, v44
    v_add_f32 v34, v34, v38
    v_add_f32 v42, v42, v46
    v_add_f32 v32, v32, v40
    v_add_f32 v34, v34, v42
    v_cvt_pk_bf16_f32 v32, v32, v34
    v_lshlrev_b32 v5, 2, v4
    ds_write_b32 v5, v32 offset:16384
    s_waitcnt lgkmcnt(0)
    s_barrier
    s_barrier
    s_branch L_Y_A_DONE
L_Y_UK:
    s_mov_b32 s40, s10
    s_and_b32 s41, s11, 0xffff
    s_mov_b32 s42, 0x400000
    s_mov_b32 s43, 0x20000
    s_lshl_b32 s57, s54, 14
    s_lshl_b32 s58, s55, 12
    s_add_u32 s57, s57, s58
    s_lshl_b32 s58, s3, 10
    s_add_u32 s57, s57, s58
    s_add_u32 s57, s57, 0x7ff000
    v_lshlrev_b32 v3, 4, v0
    buffer_load_dwordx4 v[248:251], v3, s[32:35], s57 offen
    s_waitcnt lgkmcnt(0)
    s_add_u32 s30, s30, 0x9e3779b1

    s_lshl_b32 s56, s55, 7
    s_sub_u32 s57, s3, 4
    s_lshl_b32 s59, s57, 13
    s_add_u32 s59, s59, 24576
    s_lshl_b32 s57, s57, 5
    s_add_u32 s56, s56, s57
    s_lshl_b32 s58, s56, 13
    s_lshl_b32 s57, s54, 8
    s_add_u32 s58, s58, s57
    v_xor_b32 v3, v1, v2
    v_lshlrev_b32 v3, 4, v3
    v_lshl_add_u32 v3, v2, 13, v3
    v_xor_b32 v9, 64, v3
    v_xor_b32 v10, 0x80, v3
    v_xor_b32 v11, 0xc0, v3
    s_mov_b32 s60, s59
    s_barrier
    s_mov_b32 m0, s60
    s_add_u32 s60, s60, 1024
    buffer_load_dwordx4 v3, s[40:43], s58 offen nt lds
    s_add_u32 s58, s58, 32768
    s_mov_b32 m0, s60
    s_add_u32 s60, s60, 1024
    buffer_load_dwordx4 v9, s[40:43], s58 offen nt lds
    s_add_u32 s58, s58, 32768
    s_mov_b32 m0, s60
    s_add_u32 s60, s60, 1024
    buffer_load_dwordx4 v10, s[40:43], s58 offen nt lds
    s_add_u32 s58, s58, 32768
    s_mov_b32 m0, s60
    s_add_u32 s60, s60, 1024
    buffer_load_dwordx4 v11, s[40:43], s58 offen nt lds
    s_add_u32 s58, s58, 32768
    s_mov_b32 m0, s60
    s_add_u32 s60, s60, 1024
    buffer_load_dwordx4 v3, s[40:43], s58 offen nt lds
    s_add_u32 s58, s58, 32768
    s_mov_b32 m0, s60
    s_add_u32 s60, s60, 1024
    buffer_load_dwordx4 v9, s[40:43], s58 offen nt lds
    s_add_u32 s58, s58, 32768
    s_mov_b32 m0, s60
    s_add_u32 s60, s60, 1024
    buffer_load_dwordx4 v10, s[40:43], s58 offen nt lds
    s_add_u32 s58, s58, 32768
    s_mov_b32 m0, s60
    s_add_u32 s60, s60, 1024
    buffer_load_dwordx4 v11, s[40:43], s58 offen nt lds
    s_add_u32 s58, s58, 32768
    v_lshrrev_b32 v3, 2, v1
    v_lshlrev_b32 v3, 3, v3
    v_and_b32 v9, 3, v1
    v_add_u32 v3, v3, v9
    v_and_b32 v9, 15, v3
    v_xor_b32 v9, v9, v2
    v_lshlrev_b32 v9, 4, v9
    v_lshl_add_u32 v3, v3, 8, v9
    v_add_u32 v3, s59, v3
    v_xor_b32 v9, 64, v3
    v_xor_b32 v10, 0x80, v3
    v_xor_b32 v11, 0xc0, v3
    v_and_b32 v4, 3, v1
    v_lshlrev_b32 v4, 8, v4
    v_lshl_add_u32 v4, v2, 4, v4
    v_lshlrev_b32 v5, 15, v1
    v_lshl_add_u32 v5, v2, 4, v5
    s_lshl_b32 s57, s54, 10
    s_lshl_b32 s58, s56, 1
    s_add_u32 s57, s57, s58
    s_add_u32 s57, s57, 0x100000
    s_mov_b32 s58, 0x3e0293ee
    s_mov_b32 s59, s58
    s_barrier
    s_waitcnt vmcnt(0)
    ds_read_b128 v[32:35], v3 offset:0
    ds_read_b128 v[36:39], v9 offset:0
    ds_read_b128 v[40:43], v10 offset:0
    ds_read_b128 v[44:47], v11 offset:0
    ds_read_b128 v[48:51], v9 offset:1024
    ds_read_b128 v[52:55], v3 offset:1024
    ds_read_b128 v[56:59], v11 offset:1024
    ds_read_b128 v[60:63], v10 offset:1024
    s_barrier
    ds_read_b128 v[8:11], v4 offset:16384
    ds_read_b128 v[12:15], v4 offset:16448
    ds_read_b128 v[16:19], v4 offset:16512
    ds_read_b128 v[20:23], v4 offset:16576
    s_waitcnt lgkmcnt(0)
    v_mfma_f32_16x16x32_bf16 v[24:27], v[32:35], v[8:11], 0
    v_mfma_f32_16x16x32_bf16 v[28:31], v[48:51], v[8:11], 0
    v_mfma_f32_16x16x32_bf16 v[24:27], v[36:39], v[12:15], v[24:27]
    v_mfma_f32_16x16x32_bf16 v[28:31], v[52:55], v[12:15], v[28:31]
    v_mfma_f32_16x16x32_bf16 v[24:27], v[40:43], v[16:19], v[24:27]
    v_mfma_f32_16x16x32_bf16 v[28:31], v[56:59], v[16:19], v[28:31]
    v_mfma_f32_16x16x32_bf16 v[24:27], v[44:47], v[20:23], v[24:27]
    v_mfma_f32_16x16x32_bf16 v[28:31], v[60:63], v[20:23], v[28:31]
    s_nop 7
    v_pk_mul_f32 v[24:25], v[24:25], s[58:59]
    v_pk_mul_f32 v[26:27], v[26:27], s[58:59]
    v_pk_mul_f32 v[28:29], v[28:29], s[58:59]
    v_pk_mul_f32 v[30:31], v[30:31], s[58:59]
    v_cvt_pk_bf16_f32 v64, v24, v25
    v_cvt_pk_bf16_f32 v65, v26, v27
    v_cvt_pk_bf16_f32 v66, v28, v29
    v_cvt_pk_bf16_f32 v67, v30, v31
    s_mov_b32 exec_lo, 0x000f000f
    s_mov_b32 exec_hi, 0x000f000f
    buffer_store_dwordx4 v[64:67], v5, s[32:35], s57 offen sc1
    s_mov_b64 exec, -1
    s_barrier
    s_branch L_Y_A_DONE
L_X:
    s_and_b32 s52, s2, 7
    s_lshr_b32 s53, s2, 3
    s_lshr_b32 s54, s52, 1
    s_getreg_b32 s63, hwreg(HW_REG_XCC_ID)
    s_cmp_ge_u32 s3, 4
    s_cbranch_scc1 L_X_NOCLR
    v_mov_b32 v20, -1
    v_mov_b32 v21, -1
    v_mov_b32 v22, -1
    v_mov_b32 v23, -1
    v_lshlrev_b32 v24, 4, v0
    s_lshl_b32 s56, s52, 16
    s_lshl_b32 s57, s53, 12
    s_add_u32 s56, s56, s57
    s_lshl_b32 s57, s3, 11
    s_add_u32 s56, s56, s57
    s_add_u32 s56, s56, 0x280000
    s_add_u32 s57, s56, 1024
    s_cmp_lt_u32 s3, 2
    s_cbranch_scc1 L_X_CLR
    s_lshl_b32 s56, s53, 14
    s_lshl_b32 s57, s52, 10
    s_add_u32 s56, s56, s57
    s_add_u32 s56, s56, 0x200000
    s_add_u32 s57, s56, 8192
    s_cmp_eq_u32 s3, 2
    s_cbranch_scc1 L_X_CLR
    v_lshrrev_b32 v25, 4, v0
    v_lshlrev_b32 v25, 15, v25
    v_and_b32 v24, 0xf0, v24
    v_add_u32 v24, v24, v25
    s_lshl_b32 s56, s52, 12
    s_lshl_b32 s57, s53, 8
    s_add_u32 s56, s56, s57
    s_add_u32 s56, s56, 0x240000
    s_add_u32 s57, s56, 0x20000
L_X_CLR:
    buffer_store_dwordx4 v[20:23], v24, s[32:35], s56 offen sc1
    buffer_store_dwordx4 v[20:23], v24, s[32:35], s57 offen sc1
L_X_NOCLR:
    s_mov_b32 s36, s6
    s_and_b32 s37, s7, 0xffff
    s_mov_b32 s38, 0x1000000
    s_mov_b32 s39, 0x20000
    s_lshl_b32 s57, s52, 21
    s_lshl_b32 s58, s53, 17
    s_add_u32 s57, s57, s58
    s_lshl_b32 s58, s3, 14
    s_add_u32 s57, s57, s58
    s_lshl_b32 s58, s3, 12
    v_lshrrev_b32 v5, 4, v0
    v_and_b32 v6, 15, v0
    v_lshlrev_b32 v7, 2, v5
    v_xor_b32 v6, v6, v7
    v_lshlrev_b32 v6, 4, v6
    v_lshl_add_u32 v1, v5, 10, v6
    v_xor_b32 v2, 16, v1
    v_add_u32 v2, 3072, v2
    v_xor_b32 v3, 32, v1
    v_add_u32 v3, 6144, v3
    v_xor_b32 v4, 48, v1
    v_add_u32 v4, 9216, v4
    s_cmp_lg_u32 s3, 7
    s_cbranch_scc1 L_X_NOPUB
    s_mov_b32 s60, s57
    v_mov_b32 v9, v4
    s_waitcnt lgkmcnt(0)
    s_add_u32 s30, s30, 0x9e3779b1
    s_and_b32 s56, s2, 7
    s_lshl_b32 s56, s56, 5
    s_lshr_b32 s57, s2, 3
    s_add_u32 s56, s56, s57
    s_lshl_b32 s56, s56, 4
    s_add_u32 s56, s56, 0x1000
    v_mov_b32 v4, s63
    v_mov_b32 v5, s30
    v_mov_b32 v6, s63
    v_mov_b32 v7, s30
    v_mov_b32 v8, 0
    s_mov_b64 exec, 1
    buffer_store_dwordx4 v[4:7], v8, s[32:35], s56 offen sc1
    s_mov_b64 exec, -1
    s_sub_u32 s30, s30, 0x9e3779b1
    s_mov_b32 s57, s60
    v_mov_b32 v4, v9
L_X_NOPUB:
    s_add_u32 m0, s58, 0
    s_nop 0
    buffer_load_dwordx4 v1, s[36:39], s57 offen offset:0 nt lds
    s_add_u32 m0, s58, 32512
    s_waitcnt vmcnt(0)
    buffer_load_dwordx4 v1, s[36:39], s57 offen offset:256 nt lds
    s_add_u32 m0, s58, 65024
    s_waitcnt vmcnt(0)
    buffer_load_dwordx4 v1, s[36:39], s57 offen offset:512 nt lds
    s_add_u32 m0, s58, 97536
    s_nop 0
    buffer_load_dwordx4 v1, s[36:39], s57 offen offset:768 nt lds
    s_add_u32 m0, s58, 0
    s_nop 0
    buffer_load_dwordx4 v2, s[36:39], s57 offen offset:1024 nt lds
    s_add_u32 m0, s58, 32512
    s_nop 0
    buffer_load_dwordx4 v2, s[36:39], s57 offen offset:1280 nt lds
    s_add_u32 m0, s58, 65024
    s_waitcnt vmcnt(5)
    buffer_load_dwordx4 v2, s[36:39], s57 offen offset:1536 nt lds
    s_add_u32 m0, s58, 97536
    s_waitcnt vmcnt(5)
    buffer_load_dwordx4 v2, s[36:39], s57 offen offset:1792 nt lds
    s_add_u32 m0, s58, 0
    s_waitcnt vmcnt(5)
    buffer_load_dwordx4 v3, s[36:39], s57 offen offset:2048 nt lds
    s_add_u32 m0, s58, 32512
    s_waitcnt vmcnt(5)
    buffer_load_dwordx4 v3, s[36:39], s57 offen offset:2304 nt lds
    s_add_u32 m0, s58, 65024
    s_waitcnt vmcnt(5)
    buffer_load_dwordx4 v3, s[36:39], s57 offen offset:2560 nt lds
    s_add_u32 m0, s58, 97536
    s_waitcnt vmcnt(5)
    buffer_load_dwordx4 v3, s[36:39], s57 offen offset:2816 nt lds
    s_lshl_b32 s59, s3, 9
    s_add_u32 s59, s59, 0x1100
    v_and_b32 v15, 15, v0
    v_lshlrev_b32 v15, 4, v15
    buffer_load_dwordx4 v[16:19], v15, s[32:35], s59 offen sc1
    s_add_u32 m0, s58, 0
    s_waitcnt vmcnt(5)
    buffer_load_dwordx4 v4, s[36:39], s57 offen offset:3072 nt lds
    s_add_u32 m0, s58, 32512
    s_waitcnt vmcnt(5)
    buffer_load_dwordx4 v4, s[36:39], s57 offen offset:3328 nt lds
    s_add_u32 m0, s58, 65024
    s_waitcnt vmcnt(5)
    buffer_load_dwordx4 v4, s[36:39], s57 offen offset:3584 nt lds
    s_add_u32 m0, s58, 97536
    s_waitcnt vmcnt(5)
    buffer_load_dwordx4 v4, s[36:39], s57 offen offset:3840 nt lds
    s_lshl_b32 s60, s54, 15
    s_lshl_b32 s56, s3, 12
    s_add_u32 s60, s60, s56
    s_add_u32 s60, s60, 0x100000
    v_lshlrev_b32 v12, 4, v0
    v_lshlrev_b32 v13, 5, v0
    s_and_b32 s61, s3, 3
    v_xor_b32 v9, s61, v0
    v_lshlrev_b32 v9, 4, v9
    s_add_u32 s56, s56, 0x20000
    v_add_u32 v64, s56, v9
    v_xor_b32 v65, 64, v64
    v_xor_b32 v66, 0x80, v64
    v_xor_b32 v67, 0xc0, v64
    s_waitcnt vmcnt(4) lgkmcnt(0)
    s_add_u32 s30, s30, 0x9e3779b1
L_X_PCHK:
    v_cmpx_eq_u32 vcc, s30, v17
    v_cmpx_eq_u32 vcc, s30, v19
    s_cmp_eq_u64 exec, -1
    s_mov_b64 exec, -1
    s_cbranch_scc1 L_X_POK
    s_sleep 4
    buffer_load_dwordx4 v[16:19], v15, s[32:35], s59 offen sc1
    s_waitcnt vmcnt(0)
    s_add_u32 s31, s31, 1
    s_cmp_lt_u32 s31, 100000
    s_cbranch_scc1 L_X_PCHK
    s_branch L_BAIL
L_X_POK:
    s_waitcnt vmcnt(63)
    s_barrier
    buffer_load_dwordx4 v[32:35], v12, s[32:35], s60 offen offset:0 sc1
    buffer_load_dwordx4 v[36:39], v12, s[32:35], s60 offen offset:1024 sc1
    buffer_load_dwordx4 v[40:43], v12, s[32:35], s60 offen offset:2048 sc1
    buffer_load_dwordx4 v[44:47], v12, s[32:35], s60 offen offset:3072 sc1
    s_lshl_b32 s59, s52, 9
    s_add_u32 s59, s59, 0x1000
    v_and_b32 v15, 31, v0
    v_lshlrev_b32 v15, 4, v15
    buffer_load_dwordx4 v[16:19], v15, s[32:35], s59 offen sc1
    s_cmp_lt_u32 s3, 4
    s_cbranch_scc1 L_X_SADDR
    v_bfe_u32 v1, v0, 2, 2
    v_lshrrev_b32 v2, 5, v0
    v_bfe_u32 v3, v0, 4, 1
    v_bfe_u32 v4, v0, 1, 1
    v_lshl_or_b32 v4, v3, 1, v4
    v_lshl_or_b32 v3, v1, 2, v2
    v_xor_b32 v4, v4, v3
    v_lshlrev_b32 v4, 4, v4
    v_and_b32 v3, 1, v0
    v_lshl_or_b32 v4, v3, 3, v4
    v_lshl_or_b32 v3, v2, 2, v1
    v_lshl_add_u32 v20, v3, 8, v4
    s_sub_u32 s56, s3, 4
    s_lshl_b32 s56, s56, 15
    v_add_u32 v20, s56, v20
    v_xor_b32 v21, 0x20, v20
    v_xor_b32 v22, 0x40, v20
    v_xor_b32 v23, 0x60, v20
    v_xor_b32 v24, 0x80, v20
    v_xor_b32 v25, 0xa0, v20
    v_xor_b32 v26, 0xc0, v20
    v_xor_b32 v27, 0xe0, v20
    s_branch L_X_QW
L_X_SADDR:
    s_lshl_b32 s62, s52, 15
    s_lshl_b32 s57, s53, 11
    s_add_u32 s62, s62, s57
    s_add_u32 s62, s62, 0x140000
    v_lshlrev_b32 v13, 5, v0
    s_setprio 2
    v_and_b32 v1, 31, v0
    v_lshrrev_b32 v2, 5, v0
    v_and_b32 v3, 3, v1
    v_lshlrev_b32 v3, 2, v3
    v_bfe_u32 v9, v1, 2, 2
    v_or_b32 v3, v3, v9
    v_xor_b32 v3, v3, v2
    v_lshlrev_b32 v3, 4, v3
    v_lshl_add_u32 v4, v1, 8, v3
    v_lshl_add_u32 v3, v1, 10, v3
    s_lshl_b32 s56, s3, 13
    v_add_u32 v4, s56, v4
    v_add_u32 v3, 0x20000, v3
    v_xor_b32 v24, 0x0, v3
    v_xor_b32 v96, 0x0, v4
    v_xor_b32 v25, 0x20, v3
    v_xor_b32 v97, 0x20, v4
    v_xor_b32 v26, 0x40, v3
    v_xor_b32 v98, 0x40, v4
    v_xor_b32 v27, 0x60, v3
    v_xor_b32 v99, 0x60, v4
    v_xor_b32 v28, 0x80, v3
    v_xor_b32 v100, 0x80, v4
    v_xor_b32 v29, 0xa0, v3
    v_xor_b32 v101, 0xa0, v4
    v_xor_b32 v30, 0xc0, v3
    v_xor_b32 v102, 0xc0, v4
    v_xor_b32 v31, 0xe0, v3
    v_xor_b32 v103, 0xe0, v4
    v_add_u32 v104, 0x10000, v96
    v_add_u32 v105, 0x10000, v97
    v_add_u32 v106, 0x10000, v98
    v_add_u32 v107, 0x10000, v99
    v_add_u32 v108, 0x10000, v100
    v_add_u32 v109, 0x10000, v101
    v_add_u32 v110, 0x10000, v102
    v_add_u32 v111, 0x10000, v103
L_X_QW:
    s_waitcnt vmcnt(1)
L_X_QCHK:
    v_cmpx_ne_u32 vcc, -1, v32
    v_cmpx_ne_u32 vcc, -1, v33
    v_cmpx_ne_u32 vcc, -1, v34
    v_cmpx_ne_u32 vcc, -1, v35
    v_cmpx_ne_u32 vcc, -1, v36
    v_cmpx_ne_u32 vcc, -1, v37
    v_cmpx_ne_u32 vcc, -1, v38
    v_cmpx_ne_u32 vcc, -1, v39
    v_cmpx_ne_u32 vcc, -1, v40
    v_cmpx_ne_u32 vcc, -1, v41
    v_cmpx_ne_u32 vcc, -1, v42
    v_cmpx_ne_u32 vcc, -1, v43
    v_cmpx_ne_u32 vcc, -1, v44
    v_cmpx_ne_u32 vcc, -1, v45
    v_cmpx_ne_u32 vcc, -1, v46
    v_cmpx_ne_u32 vcc, -1, v47
    s_cmp_eq_u64 exec, -1
    s_mov_b64 exec, -1
    s_cbranch_scc1 L_QGOK_1
    buffer_load_dwordx4 v[32:35], v12, s[32:35], s60 offen offset:0 sc1
    buffer_load_dwordx4 v[36:39], v12, s[32:35], s60 offen offset:1024 sc1
    buffer_load_dwordx4 v[40:43], v12, s[32:35], s60 offen offset:2048 sc1
    buffer_load_dwordx4 v[44:47], v12, s[32:35], s60 offen offset:3072 sc1
    s_waitcnt vmcnt(0)
    s_add_u32 s31, s31, 1
    s_cmp_lt_u32 s31, 100000
    s_cbranch_scc1 L_X_QCHK
    s_branch L_BAIL
L_QGOK_1:
    ds_write_b128 v64, v[32:35] offset:0
    ds_write_b128 v65, v[36:39] offset:1024
    ds_write_b128 v66, v[40:43] offset:2048
    ds_write_b128 v67, v[44:47] offset:3072
    s_waitcnt lgkmcnt(0)
    s_barrier
    s_cmp_lt_u32 s3, 4
    s_cbranch_scc1 L_X_S
    s_lshl_b32 s57, s52, 19
    s_lshl_b32 s58, s53, 15
    s_add_u32 s57, s57, s58
    s_lshl_b32 s58, s3, 13
    s_add_u32 s57, s57, s58
    s_add_u32 s57, s57, 0x3f8000
    v_lshlrev_b32 v1, 7, v0
    buffer_load_dword v13, v1, s[32:35], s57 offen
    s_barrier
    ds_read_b64_tr_b16 v[128:129], v20 offset:0
    ds_read_b64_tr_b16 v[130:131], v21 offset:2048
    ds_read_b64_tr_b16 v[132:133], v20 offset:4096
    ds_read_b64_tr_b16 v[134:135], v21 offset:6144
    ds_read_b64_tr_b16 v[136:137], v20 offset:8192
    ds_read_b64_tr_b16 v[138:139], v21 offset:10240
    ds_read_b64_tr_b16 v[140:141], v20 offset:12288
    ds_read_b64_tr_b16 v[142:143], v21 offset:14336
    s_waitcnt lgkmcnt(6)
    ds_read_b64_tr_b16 v[144:145], v20 offset:16384
    ds_read_b64_tr_b16 v[146:147], v21 offset:18432
    ds_read_b64_tr_b16 v[148:149], v20 offset:20480
    ds_read_b64_tr_b16 v[150:151], v21 offset:22528
    ds_read_b64_tr_b16 v[152:153], v20 offset:24576
    ds_read_b64_tr_b16 v[154:155], v21 offset:26624
    ds_read_b64_tr_b16 v[156:157], v20 offset:28672
    ds_read_b64_tr_b16 v[158:159], v21 offset:30720
    s_waitcnt lgkmcnt(6)
    ds_read_b64_tr_b16 v[160:161], v22 offset:0
    ds_read_b64_tr_b16 v[162:163], v23 offset:2048
    ds_read_b64_tr_b16 v[164:165], v22 offset:4096
    ds_read_b64_tr_b16 v[166:167], v23 offset:6144
    ds_read_b64_tr_b16 v[168:169], v22 offset:8192
    ds_read_b64_tr_b16 v[170:171], v23 offset:10240
    ds_read_b64_tr_b16 v[172:173], v22 offset:12288
    ds_read_b64_tr_b16 v[174:175], v23 offset:14336
    s_waitcnt lgkmcnt(6)
    ds_read_b64_tr_b16 v[176:177], v22 offset:16384
    ds_read_b64_tr_b16 v[178:179], v23 offset:18432
    ds_read_b64_tr_b16 v[180:181], v22 offset:20480
    ds_read_b64_tr_b16 v[182:183], v23 offset:22528
    ds_read_b64_tr_b16 v[184:185], v22 offset:24576
    ds_read_b64_tr_b16 v[186:187], v23 offset:26624
    ds_read_b64_tr_b16 v[188:189], v22 offset:28672
    ds_read_b64_tr_b16 v[190:191], v23 offset:30720
    s_waitcnt lgkmcnt(6)
    s_barrier
    ds_read_b64_tr_b16 v[192:193], v24 offset:0
    ds_read_b64_tr_b16 v[194:195], v25 offset:2048
    ds_read_b64_tr_b16 v[196:197], v24 offset:4096
    ds_read_b64_tr_b16 v[198:199], v25 offset:6144
    ds_read_b64_tr_b16 v[200:201], v24 offset:8192
    ds_read_b64_tr_b16 v[202:203], v25 offset:10240
    ds_read_b64_tr_b16 v[204:205], v24 offset:12288
    ds_read_b64_tr_b16 v[206:207], v25 offset:14336
    s_waitcnt lgkmcnt(6)
    ds_read_b64_tr_b16 v[208:209], v24 offset:16384
    ds_read_b64_tr_b16 v[210:211], v25 offset:18432
    ds_read_b64_tr_b16 v[212:213], v24 offset:20480
    ds_read_b64_tr_b16 v[214:215], v25 offset:22528
    ds_read_b64_tr_b16 v[216:217], v24 offset:24576
    ds_read_b64_tr_b16 v[218:219], v25 offset:26624
    ds_read_b64_tr_b16 v[220:221], v24 offset:28672
    ds_read_b64_tr_b16 v[222:223], v25 offset:30720
    s_waitcnt lgkmcnt(6)
    ds_read_b64_tr_b16 v[224:225], v26 offset:0
    ds_read_b64_tr_b16 v[226:227], v27 offset:2048
    ds_read_b64_tr_b16 v[228:229], v26 offset:4096
    ds_read_b64_tr_b16 v[230:231], v27 offset:6144
    ds_read_b64_tr_b16 v[232:233], v26 offset:8192
    ds_read_b64_tr_b16 v[234:235], v27 offset:10240
    ds_read_b64_tr_b16 v[236:237], v26 offset:12288
    ds_read_b64_tr_b16 v[238:239], v27 offset:14336
    s_waitcnt lgkmcnt(6)
    ds_read_b64_tr_b16 v[240:241], v26 offset:16384
    ds_read_b64_tr_b16 v[242:243], v27 offset:18432
    ds_read_b64_tr_b16 v[244:245], v26 offset:20480
    ds_read_b64_tr_b16 v[246:247], v27 offset:22528
    ds_read_b64_tr_b16 v[248:249], v26 offset:24576
    ds_read_b64_tr_b16 v[250:251], v27 offset:26624
    ds_read_b64_tr_b16 v[252:253], v26 offset:28672
    ds_read_b64_tr_b16 v[254:255], v27 offset:30720
    s_waitcnt lgkmcnt(6)
    v_and_b32 v1, 31, v0
    v_lshrrev_b32 v2, 5, v0
    v_lshlrev_b32 v5, 4, v1
    v_lshl_add_u32 v5, v2, 10, v5
    v_add_u32 v5, 0x20000, v5
    s_sub_u32 s62, s3, 4
    s_lshl_b32 s56, s62, 13
    s_add_u32 s56, s56, 0x20200
    v_lshrrev_b32 v3, 3, v1
    v_lshlrev_b32 v3, 10, v3
    v_and_b32 v4, 7, v1
    v_lshl_add_u32 v3, v4, 6, v3
    v_lshl_add_u32 v3, v2, 3, v3
    v_bfe_u32 v4, v1, 1, 2
    v_lshl_add_u32 v3, v4, 4, v3
    v_add_u32 v8, s56, v3
    v_xor_b32 v9, 16, v8
    v_xor_b32 v10, 32, v8
    v_xor_b32 v11, 48, v8
    v_lshrrev_b32 v3, 2, v0
    v_lshrrev_b32 v4, 3, v3
    v_lshlrev_b32 v6, 10, v4
    v_and_b32 v4, 7, v3
    v_lshl_add_u32 v6, v4, 6, v6
    v_bfe_u32 v4, v3, 1, 2
    v_and_b32 v7, 3, v0
    v_xor_b32 v4, v4, v7
    v_lshl_add_u32 v6, v4, 4, v6
    v_add_u32 v6, s56, v6
    v_lshrrev_b32 v4, 1, v3
    v_lshlrev_b32 v4, 15, v4
    v_and_b32 v3, 1, v3
    v_lshl_add_u32 v4, v3, 10, v4
    v_lshl_add_u32 v7, v7, 4, v4
    s_lshl_b32 s56, s52, 19
    s_lshl_b32 s57, s53, 11
    s_add_u32 s56, s56, s57
    s_lshl_b32 s57, s62, 8
    s_add_u32 s56, s56, s57
    s_add_u32 s56, s56, 0x400000
    s_add_u32 s57, s56, 0x40000
    v_lshrrev_b32 v12, 1, v1
    v_lshlrev_b32 v12, 15, v12
    v_and_b32 v3, 1, v1
    v_lshl_add_u32 v12, v3, 10, v12
    v_lshl_add_u32 v12, v2, 4, v12
    s_waitcnt lgkmcnt(0)
    s_barrier
    ds_read_b128 v[96:99], v5 offset:0
    ds_read_b128 v[100:103], v5 offset:2048
    ds_read_b128 v[104:107], v5 offset:4096
    ds_read_b128 v[108:111], v5 offset:6144
    ds_read_b128 v[112:115], v5 offset:8192
    ds_read_b128 v[116:119], v5 offset:10240
    ds_read_b128 v[120:123], v5 offset:12288
    ds_read_b128 v[124:127], v5 offset:14336
    s_waitcnt vmcnt(1)
L_XCHK_2:
    v_cmpx_eq_u32 vcc, s30, v17
    v_cmpx_eq_u32 vcc, s30, v19
    s_cmp_eq_u64 exec, -1
    s_mov_b64 exec, -1
    s_cbranch_scc1 L_XOK_3
    buffer_load_dwordx4 v[16:19], v15, s[32:35], s59 offen sc1
    s_waitcnt vmcnt(0)
    s_add_u32 s31, s31, 1
    s_cmp_lt_u32 s31, 100000
    s_cbranch_scc1 L_XCHK_2
    s_branch L_BAIL
L_XOK_3:
    v_cmp_eq_u32 vcc, s63, v16
    s_cmp_eq_u64 vcc, -1
    s_cbranch_scc0 L_X_PVSLOW
    s_waitcnt lgkmcnt(7)
    v_mfma_f32_32x32x16_bf16 v[32:47], v[128:131], v[96:99], 0
    s_waitcnt lgkmcnt(6)
    v_mfma_f32_32x32x16_bf16 v[32:47], v[132:135], v[100:103], v[32:47]
    s_waitcnt lgkmcnt(5)
    v_mfma_f32_32x32x16_bf16 v[32:47], v[136:139], v[104:107], v[32:47]
    s_waitcnt lgkmcnt(4)
    v_mfma_f32_32x32x16_bf16 v[32:47], v[140:143], v[108:111], v[32:47]
    s_waitcnt lgkmcnt(3)
    v_mfma_f32_32x32x16_bf16 v[32:47], v[144:147], v[112:115], v[32:47]
    s_waitcnt lgkmcnt(2)
    v_mfma_f32_32x32x16_bf16 v[32:47], v[148:151], v[116:119], v[32:47]
    s_waitcnt lgkmcnt(1)
    v_mfma_f32_32x32x16_bf16 v[32:47], v[152:155], v[120:123], v[32:47]
    s_waitcnt lgkmcnt(0)
    v_mfma_f32_32x32x16_bf16 v[32:47], v[156:159], v[124:127], v[32:47]
    v_mfma_f32_32x32x16_bf16 v[48:63], v[160:163], v[96:99], 0
    v_mfma_f32_32x32x16_bf16 v[48:63], v[164:167], v[100:103], v[48:63]
    v_mfma_f32_32x32x16_bf16 v[48:63], v[168:171], v[104:107], v[48:63]
    v_cvt_pk_bf16_f32 v16, v32, v33
    v_cvt_pk_bf16_f32 v17, v34, v35
    v_cvt_pk_bf16_f32 v18, v36, v37
    v_cvt_pk_bf16_f32 v19, v38, v39
    v_mfma_f32_32x32x16_bf16 v[48:63], v[172:175], v[108:111], v[48:63]
    v_cvt_pk_bf16_f32 v20, v40, v41
    v_cvt_pk_bf16_f32 v21, v42, v43
    v_cvt_pk_bf16_f32 v22, v44, v45
    v_cvt_pk_bf16_f32 v23, v46, v47
    v_mfma_f32_32x32x16_bf16 v[48:63], v[176:179], v[112:115], v[48:63]
    ds_write_b64 v8, v[16:17] offset:0
    ds_write_b64 v9, v[18:19] offset:0
    ds_write_b64 v10, v[20:21] offset:0
    ds_write_b64 v11, v[22:23] offset:0
    v_mfma_f32_32x32x16_bf16 v[48:63], v[180:183], v[116:119], v[48:63]
    s_waitcnt lgkmcnt(0)
    ds_read_b128 v[24:27], v6 offset:0
    ds_read_b128 v[28:31], v6 offset:2048
    v_mfma_f32_32x32x16_bf16 v[48:63], v[184:187], v[120:123], v[48:63]
    v_mfma_f32_32x32x16_bf16 v[48:63], v[188:191], v[124:127], v[48:63]
    s_waitcnt lgkmcnt(1)
    buffer_store_dwordx4 v[24:27], v7, s[32:35], s56 offen offset:0
    s_waitcnt lgkmcnt(0)
    buffer_store_dwordx4 v[28:31], v7, s[32:35], s57 offen offset:0
    v_mfma_f32_32x32x16_bf16 v[64:79], v[192:195], v[96:99], 0
    v_mfma_f32_32x32x16_bf16 v[64:79], v[196:199], v[100:103], v[64:79]
    v_mfma_f32_32x32x16_bf16 v[64:79], v[200:203], v[104:107], v[64:79]
    v_cvt_pk_bf16_f32 v16, v48, v49
    v_cvt_pk_bf16_f32 v17, v50, v51
    v_cvt_pk_bf16_f32 v18, v52, v53
    v_cvt_pk_bf16_f32 v19, v54, v55
    v_mfma_f32_32x32x16_bf16 v[64:79], v[204:207], v[108:111], v[64:79]
    v_cvt_pk_bf16_f32 v20, v56, v57
    v_cvt_pk_bf16_f32 v21, v58, v59
    v_cvt_pk_bf16_f32 v22, v60, v61
    v_cvt_pk_bf16_f32 v23, v62, v63
    v_mfma_f32_32x32x16_bf16 v[64:79], v[208:211], v[112:115], v[64:79]
    ds_write_b64 v8, v[16:17] offset:4096
    ds_write_b64 v9, v[18:19] offset:4096
    ds_write_b64 v10, v[20:21] offset:4096
    ds_write_b64 v11, v[22:23] offset:4096
    v_mfma_f32_32x32x16_bf16 v[64:79], v[212:215], v[116:119], v[64:79]
    s_waitcnt lgkmcnt(0)
    ds_read_b128 v[24:27], v6 offset:4096
    ds_read_b128 v[28:31], v6 offset:6144
    v_mfma_f32_32x32x16_bf16 v[64:79], v[216:219], v[120:123], v[64:79]
    v_mfma_f32_32x32x16_bf16 v[64:79], v[220:223], v[124:127], v[64:79]
    s_waitcnt lgkmcnt(1)
    buffer_store_dwordx4 v[24:27], v7, s[32:35], s56 offen offset:64
    s_waitcnt lgkmcnt(0)
    buffer_store_dwordx4 v[28:31], v7, s[32:35], s57 offen offset:64
    v_mfma_f32_32x32x16_bf16 v[80:95], v[224:227], v[96:99], 0
    v_mfma_f32_32x32x16_bf16 v[80:95], v[228:231], v[100:103], v[80:95]
    v_mfma_f32_32x32x16_bf16 v[80:95], v[232:235], v[104:107], v[80:95]
    v_cvt_pk_bf16_f32 v16, v64, v65
    v_cvt_pk_bf16_f32 v17, v66, v67
    v_cvt_pk_bf16_f32 v18, v68, v69
    v_cvt_pk_bf16_f32 v19, v70, v71
    v_mfma_f32_32x32x16_bf16 v[80:95], v[236:239], v[108:111], v[80:95]
    v_cvt_pk_bf16_f32 v20, v72, v73
    v_cvt_pk_bf16_f32 v21, v74, v75
    v_cvt_pk_bf16_f32 v22, v76, v77
    v_cvt_pk_bf16_f32 v23, v78, v79
    v_mfma_f32_32x32x16_bf16 v[80:95], v[240:243], v[112:115], v[80:95]
    ds_write_b64 v8, v[16:17] offset:0
    ds_write_b64 v9, v[18:19] offset:0
    ds_write_b64 v10, v[20:21] offset:0
    ds_write_b64 v11, v[22:23] offset:0
    v_mfma_f32_32x32x16_bf16 v[80:95], v[244:247], v[116:119], v[80:95]
    s_waitcnt lgkmcnt(0)
    ds_read_b128 v[24:27], v6 offset:0
    ds_read_b128 v[28:31], v6 offset:2048
    v_mfma_f32_32x32x16_bf16 v[80:95], v[248:251], v[120:123], v[80:95]
    v_mfma_f32_32x32x16_bf16 v[80:95], v[252:255], v[124:127], v[80:95]
    s_waitcnt lgkmcnt(1)
    buffer_store_dwordx4 v[24:27], v7, s[32:35], s56 offen offset:128
    s_waitcnt lgkmcnt(0)
    buffer_store_dwordx4 v[28:31], v7, s[32:35], s57 offen offset:128
    s_nop 11
    v_cvt_pk_bf16_f32 v16, v80, v81
    v_cvt_pk_bf16_f32 v17, v82, v83
    v_cvt_pk_bf16_f32 v18, v84, v85
    v_cvt_pk_bf16_f32 v19, v86, v87
    v_cvt_pk_bf16_f32 v20, v88, v89
    v_cvt_pk_bf16_f32 v21, v90, v91
    v_cvt_pk_bf16_f32 v22, v92, v93
    v_cvt_pk_bf16_f32 v23, v94, v95
    ds_write_b64 v8, v[16:17] offset:4096
    ds_write_b64 v9, v[18:19] offset:4096
    ds_write_b64 v10, v[20:21] offset:4096
    ds_write_b64 v11, v[22:23] offset:4096
    s_waitcnt lgkmcnt(0)
    ds_read_b128 v[24:27], v6 offset:4096
    ds_read_b128 v[28:31], v6 offset:6144
    s_waitcnt lgkmcnt(1)
    buffer_store_dwordx4 v[24:27], v7, s[32:35], s56 offen offset:192
    s_waitcnt lgkmcnt(0)
    buffer_store_dwordx4 v[28:31], v7, s[32:35], s57 offen offset:192
    s_lshl_b32 s58, s52, 8
    s_lshl_b32 s59, s53, 4
    s_add_u32 s58, s58, s59
    s_lshl_b32 s59, s62, 2
    s_add_u32 s58, s58, s59
    s_add_u32 s58, s58, 0x8000
    v_mov_b32 v4, s30
    v_mov_b32 v5, 0
    s_mov_b64 exec, 1
    s_waitcnt vmcnt(0)
    buffer_store_dword v4, v5, s[32:35], s58 offen
    s_mov_b64 exec, -1
    s_branch L_FIN
L_X_PVSLOW:
    s_waitcnt lgkmcnt(7)
    v_mfma_f32_32x32x16_bf16 v[32:47], v[128:131], v[96:99], 0
    s_waitcnt lgkmcnt(6)
    v_mfma_f32_32x32x16_bf16 v[32:47], v[132:135], v[100:103], v[32:47]
    s_waitcnt lgkmcnt(5)
    v_mfma_f32_32x32x16_bf16 v[32:47], v[136:139], v[104:107], v[32:47]
    s_waitcnt lgkmcnt(4)
    v_mfma_f32_32x32x16_bf16 v[32:47], v[140:143], v[108:111], v[32:47]
    s_waitcnt lgkmcnt(3)
    v_mfma_f32_32x32x16_bf16 v[32:47], v[144:147], v[112:115], v[32:47]
    s_waitcnt lgkmcnt(2)
    v_mfma_f32_32x32x16_bf16 v[32:47], v[148:151], v[116:119], v[32:47]
    s_waitcnt lgkmcnt(1)
    v_mfma_f32_32x32x16_bf16 v[32:47], v[152:155], v[120:123], v[32:47]
    s_waitcnt lgkmcnt(0)
    v_mfma_f32_32x32x16_bf16 v[32:47], v[156:159], v[124:127], v[32:47]
    v_mfma_f32_32x32x16_bf16 v[48:63], v[160:163], v[96:99], 0
    v_mfma_f32_32x32x16_bf16 v[48:63], v[164:167], v[100:103], v[48:63]
    v_mfma_f32_32x32x16_bf16 v[48:63], v[168:171], v[104:107], v[48:63]
    v_cvt_pk_bf16_f32 v16, v32, v33
    v_cvt_pk_bf16_f32 v17, v34, v35
    v_cvt_pk_bf16_f32 v18, v36, v37
    v_cvt_pk_bf16_f32 v19, v38, v39
    v_mfma_f32_32x32x16_bf16 v[48:63], v[172:175], v[108:111], v[48:63]
    v_cvt_pk_bf16_f32 v20, v40, v41
    v_cvt_pk_bf16_f32 v21, v42, v43
    v_cvt_pk_bf16_f32 v22, v44, v45
    v_cvt_pk_bf16_f32 v23, v46, v47
    v_mfma_f32_32x32x16_bf16 v[48:63], v[176:179], v[112:115], v[48:63]
    ds_write_b64 v8, v[16:17] offset:0
    ds_write_b64 v9, v[18:19] offset:0
    ds_write_b64 v10, v[20:21] offset:0
    ds_write_b64 v11, v[22:23] offset:0
    v_mfma_f32_32x32x16_bf16 v[48:63], v[180:183], v[116:119], v[48:63]
    s_waitcnt lgkmcnt(0)
    ds_read_b128 v[24:27], v6 offset:0
    ds_read_b128 v[28:31], v6 offset:2048
    v_mfma_f32_32x32x16_bf16 v[48:63], v[184:187], v[120:123], v[48:63]
    v_mfma_f32_32x32x16_bf16 v[48:63], v[188:191], v[124:127], v[48:63]
    s_waitcnt lgkmcnt(1)
    buffer_store_dwordx4 v[24:27], v7, s[32:35], s56 offen offset:0 sc1
    s_waitcnt lgkmcnt(0)
    buffer_store_dwordx4 v[28:31], v7, s[32:35], s57 offen offset:0 sc1
    v_mfma_f32_32x32x16_bf16 v[64:79], v[192:195], v[96:99], 0
    v_mfma_f32_32x32x16_bf16 v[64:79], v[196:199], v[100:103], v[64:79]
    v_mfma_f32_32x32x16_bf16 v[64:79], v[200:203], v[104:107], v[64:79]
    v_cvt_pk_bf16_f32 v16, v48, v49
    v_cvt_pk_bf16_f32 v17, v50, v51
    v_cvt_pk_bf16_f32 v18, v52, v53
    v_cvt_pk_bf16_f32 v19, v54, v55
    v_mfma_f32_32x32x16_bf16 v[64:79], v[204:207], v[108:111], v[64:79]
    v_cvt_pk_bf16_f32 v20, v56, v57
    v_cvt_pk_bf16_f32 v21, v58, v59
    v_cvt_pk_bf16_f32 v22, v60, v61
    v_cvt_pk_bf16_f32 v23, v62, v63
    v_mfma_f32_32x32x16_bf16 v[64:79], v[208:211], v[112:115], v[64:79]
    ds_write_b64 v8, v[16:17] offset:4096
    ds_write_b64 v9, v[18:19] offset:4096
    ds_write_b64 v10, v[20:21] offset:4096
    ds_write_b64 v11, v[22:23] offset:4096
    v_mfma_f32_32x32x16_bf16 v[64:79], v[212:215], v[116:119], v[64:79]
    s_waitcnt lgkmcnt(0)
    ds_read_b128 v[24:27], v6 offset:4096
    ds_read_b128 v[28:31], v6 offset:6144
    v_mfma_f32_32x32x16_bf16 v[64:79], v[216:219], v[120:123], v[64:79]
    v_mfma_f32_32x32x16_bf16 v[64:79], v[220:223], v[124:127], v[64:79]
    s_waitcnt lgkmcnt(1)
    buffer_store_dwordx4 v[24:27], v7, s[32:35], s56 offen offset:64 sc1
    s_waitcnt lgkmcnt(0)
    buffer_store_dwordx4 v[28:31], v7, s[32:35], s57 offen offset:64 sc1
    v_mfma_f32_32x32x16_bf16 v[80:95], v[224:227], v[96:99], 0
    v_mfma_f32_32x32x16_bf16 v[80:95], v[228:231], v[100:103], v[80:95]
    v_mfma_f32_32x32x16_bf16 v[80:95], v[232:235], v[104:107], v[80:95]
    v_cvt_pk_bf16_f32 v16, v64, v65
    v_cvt_pk_bf16_f32 v17, v66, v67
    v_cvt_pk_bf16_f32 v18, v68, v69
    v_cvt_pk_bf16_f32 v19, v70, v71
    v_mfma_f32_32x32x16_bf16 v[80:95], v[236:239], v[108:111], v[80:95]
    v_cvt_pk_bf16_f32 v20, v72, v73
    v_cvt_pk_bf16_f32 v21, v74, v75
    v_cvt_pk_bf16_f32 v22, v76, v77
    v_cvt_pk_bf16_f32 v23, v78, v79
    v_mfma_f32_32x32x16_bf16 v[80:95], v[240:243], v[112:115], v[80:95]
    ds_write_b64 v8, v[16:17] offset:0
    ds_write_b64 v9, v[18:19] offset:0
    ds_write_b64 v10, v[20:21] offset:0
    ds_write_b64 v11, v[22:23] offset:0
    v_mfma_f32_32x32x16_bf16 v[80:95], v[244:247], v[116:119], v[80:95]
    s_waitcnt lgkmcnt(0)
    ds_read_b128 v[24:27], v6 offset:0
    ds_read_b128 v[28:31], v6 offset:2048
    v_mfma_f32_32x32x16_bf16 v[80:95], v[248:251], v[120:123], v[80:95]
    v_mfma_f32_32x32x16_bf16 v[80:95], v[252:255], v[124:127], v[80:95]
    s_waitcnt lgkmcnt(1)
    buffer_store_dwordx4 v[24:27], v7, s[32:35], s56 offen offset:128 sc1
    s_waitcnt lgkmcnt(0)
    buffer_store_dwordx4 v[28:31], v7, s[32:35], s57 offen offset:128 sc1
    s_nop 11
    v_cvt_pk_bf16_f32 v16, v80, v81
    v_cvt_pk_bf16_f32 v17, v82, v83
    v_cvt_pk_bf16_f32 v18, v84, v85
    v_cvt_pk_bf16_f32 v19, v86, v87
    v_cvt_pk_bf16_f32 v20, v88, v89
    v_cvt_pk_bf16_f32 v21, v90, v91
    v_cvt_pk_bf16_f32 v22, v92, v93
    v_cvt_pk_bf16_f32 v23, v94, v95
    ds_write_b64 v8, v[16:17] offset:4096
    ds_write_b64 v9, v[18:19] offset:4096
    ds_write_b64 v10, v[20:21] offset:4096
    ds_write_b64 v11, v[22:23] offset:4096
    s_waitcnt lgkmcnt(0)
    ds_read_b128 v[24:27], v6 offset:4096
    ds_read_b128 v[28:31], v6 offset:6144
    s_waitcnt lgkmcnt(1)
    buffer_store_dwordx4 v[24:27], v7, s[32:35], s56 offen offset:192 sc1
    s_waitcnt lgkmcnt(0)
    buffer_store_dwordx4 v[28:31], v7, s[32:35], s57 offen offset:192 sc1
    s_lshl_b32 s58, s52, 8
    s_lshl_b32 s59, s53, 4
    s_add_u32 s58, s58, s59
    s_lshl_b32 s59, s62, 2
    s_add_u32 s58, s58, s59
    s_add_u32 s58, s58, 0x8000
    v_mov_b32 v4, s30
    v_mov_b32 v5, 0
    s_mov_b64 exec, 1
    s_waitcnt vmcnt(0)
    buffer_store_dword v4, v5, s[32:35], s58 offen sc1
    s_mov_b64 exec, -1
    s_branch L_FIN
L_X_S:
    ds_read_b128 v[128:131], v96 offset:0
    ds_read_b128 v[132:135], v24 offset:0
    ds_read_b128 v[136:139], v97 offset:0
    ds_read_b128 v[140:143], v25 offset:0
    ds_read_b128 v[144:147], v98 offset:0
    ds_read_b128 v[148:151], v26 offset:0
    ds_read_b128 v[152:155], v99 offset:0
    ds_read_b128 v[156:159], v27 offset:0
    s_waitcnt lgkmcnt(6)
    v_mfma_f32_32x32x16_bf16 v[64:79], v[128:131], v[132:135], 0
    ds_read_b128 v[128:131], v100 offset:0
    ds_read_b128 v[132:135], v28 offset:0
    s_waitcnt lgkmcnt(6)
    v_mfma_f32_32x32x16_bf16 v[64:79], v[136:139], v[140:143], v[64:79]
    ds_read_b128 v[136:139], v101 offset:0
    ds_read_b128 v[140:143], v29 offset:0
    s_waitcnt lgkmcnt(6)
    v_mfma_f32_32x32x16_bf16 v[64:79], v[144:147], v[148:151], v[64:79]
    ds_read_b128 v[144:147], v102 offset:0
    ds_read_b128 v[148:151], v30 offset:0
    s_waitcnt lgkmcnt(6)
    v_mfma_f32_32x32x16_bf16 v[64:79], v[152:155], v[156:159], v[64:79]
    ds_read_b128 v[152:155], v103 offset:0
    ds_read_b128 v[156:159], v31 offset:0
    s_waitcnt lgkmcnt(6)
    v_mfma_f32_32x32x16_bf16 v[64:79], v[128:131], v[132:135], v[64:79]
    ds_read_b128 v[128:131], v96 offset:32768
    ds_read_b128 v[132:135], v24 offset:256
    s_waitcnt lgkmcnt(6)
    v_mfma_f32_32x32x16_bf16 v[64:79], v[136:139], v[140:143], v[64:79]
    ds_read_b128 v[136:139], v97 offset:32768
    ds_read_b128 v[140:143], v25 offset:256
    s_waitcnt lgkmcnt(6)
    v_mfma_f32_32x32x16_bf16 v[64:79], v[144:147], v[148:151], v[64:79]
    ds_read_b128 v[144:147], v98 offset:32768
    ds_read_b128 v[148:151], v26 offset:256
    s_waitcnt lgkmcnt(6)
    v_mfma_f32_32x32x16_bf16 v[64:79], v[152:155], v[156:159], v[64:79]
    ds_read_b128 v[152:155], v99 offset:32768
    ds_read_b128 v[156:159], v27 offset:256
    s_waitcnt lgkmcnt(6)
    v_mfma_f32_32x32x16_bf16 v[64:79], v[128:131], v[132:135], v[64:79]
    ds_read_b128 v[128:131], v100 offset:32768
    ds_read_b128 v[132:135], v28 offset:256
    s_waitcnt lgkmcnt(6)
    v_mfma_f32_32x32x16_bf16 v[64:79], v[136:139], v[140:143], v[64:79]
    ds_read_b128 v[136:139], v101 offset:32768
    ds_read_b128 v[140:143], v29 offset:256
    s_waitcnt lgkmcnt(6)
    v_mfma_f32_32x32x16_bf16 v[64:79], v[144:147], v[148:151], v[64:79]
    ds_read_b128 v[144:147], v102 offset:32768
    ds_read_b128 v[148:151], v30 offset:256
    s_waitcnt lgkmcnt(6)
    v_mfma_f32_32x32x16_bf16 v[64:79], v[152:155], v[156:159], v[64:79]
    ds_read_b128 v[152:155], v103 offset:32768
    ds_read_b128 v[156:159], v31 offset:256
    s_waitcnt lgkmcnt(6)
    v_mfma_f32_32x32x16_bf16 v[64:79], v[128:131], v[132:135], v[64:79]
    ds_read_b128 v[128:131], v104 offset:0
    ds_read_b128 v[132:135], v24 offset:512
    s_waitcnt lgkmcnt(6)
    v_mfma_f32_32x32x16_bf16 v[64:79], v[136:139], v[140:143], v[64:79]
    ds_read_b128 v[136:139], v105 offset:0
    ds_read_b128 v[140:143], v25 offset:512
    s_waitcnt lgkmcnt(6)
    v_mfma_f32_32x32x16_bf16 v[64:79], v[144:147], v[148:151], v[64:79]
    ds_read_b128 v[144:147], v106 offset:0
    ds_read_b128 v[148:151], v26 offset:512
    s_waitcnt lgkmcnt(6)
    v_mfma_f32_32x32x16_bf16 v[64:79], v[152:155], v[156:159], v[64:79]
    ds_read_b128 v[152:155], v107 offset:0
    ds_read_b128 v[156:159], v27 offset:512
    s_waitcnt lgkmcnt(6)
    v_mfma_f32_32x32x16_bf16 v[64:79], v[128:131], v[132:135], v[64:79]
    ds_read_b128 v[128:131], v108 offset:0
    ds_read_b128 v[132:135], v28 offset:512
    s_waitcnt lgkmcnt(6)
    v_mfma_f32_32x32x16_bf16 v[64:79], v[136:139], v[140:143], v[64:79]
    ds_read_b128 v[136:139], v109 offset:0
    ds_read_b128 v[140:143], v29 offset:512
    s_waitcnt lgkmcnt(6)
    v_mfma_f32_32x32x16_bf16 v[64:79], v[144:147], v[148:151], v[64:79]
    ds_read_b128 v[144:147], v110 offset:0
    ds_read_b128 v[148:151], v30 offset:512
    s_waitcnt lgkmcnt(6)
    v_mfma_f32_32x32x16_bf16 v[64:79], v[152:155], v[156:159], v[64:79]
    ds_read_b128 v[152:155], v111 offset:0
    ds_read_b128 v[156:159], v31 offset:512
    s_waitcnt lgkmcnt(6)
    v_mfma_f32_32x32x16_bf16 v[64:79], v[128:131], v[132:135], v[64:79]
    ds_read_b128 v[32:35], v24 offset:768
    ds_read_b128 v[36:39], v25 offset:768
    s_waitcnt lgkmcnt(6)
    v_mfma_f32_32x32x16_bf16 v[64:79], v[136:139], v[140:143], v[64:79]
    ds_read_b128 v[40:43], v26 offset:768
    ds_read_b128 v[44:47], v27 offset:768
    s_waitcnt lgkmcnt(6)
    v_mfma_f32_32x32x16_bf16 v[64:79], v[144:147], v[148:151], v[64:79]
    ds_read_b128 v[48:51], v28 offset:768
    ds_read_b128 v[52:55], v29 offset:768
    s_waitcnt lgkmcnt(6)
    v_mfma_f32_32x32x16_bf16 v[64:79], v[152:155], v[156:159], v[64:79]
    ds_read_b128 v[56:59], v30 offset:768
    ds_read_b128 v[60:63], v31 offset:768
    s_waitcnt lgkmcnt(0)
    s_barrier
    ds_read_b128 v[160:163], v104 offset:32768
    ds_read_b128 v[164:167], v105 offset:32768
    ds_read_b128 v[168:171], v106 offset:32768
    ds_read_b128 v[172:175], v107 offset:32768
    ds_read_b128 v[176:179], v108 offset:32768
    ds_read_b128 v[180:183], v109 offset:32768
    ds_read_b128 v[184:187], v110 offset:32768
    ds_read_b128 v[188:191], v111 offset:32768
    s_waitcnt lgkmcnt(7)
    v_mfma_f32_32x32x16_bf16 v[64:79], v[160:163], v[32:35], v[64:79]
    s_waitcnt lgkmcnt(6)
    v_mfma_f32_32x32x16_bf16 v[64:79], v[164:167], v[36:39], v[64:79]
    s_waitcnt lgkmcnt(5)
    v_mfma_f32_32x32x16_bf16 v[64:79], v[168:171], v[40:43], v[64:79]
    s_waitcnt lgkmcnt(4)
    v_mfma_f32_32x32x16_bf16 v[64:79], v[172:175], v[44:47], v[64:79]
    s_waitcnt lgkmcnt(3)
    v_mfma_f32_32x32x16_bf16 v[64:79], v[176:179], v[48:51], v[64:79]
    s_waitcnt lgkmcnt(2)
    v_mfma_f32_32x32x16_bf16 v[64:79], v[180:183], v[52:55], v[64:79]
    s_waitcnt lgkmcnt(1)
    v_mfma_f32_32x32x16_bf16 v[64:79], v[184:187], v[56:59], v[64:79]
    s_waitcnt lgkmcnt(0)
    v_mfma_f32_32x32x16_bf16 v[64:79], v[188:191], v[60:63], v[64:79]
    s_lshl_b32 s56, s3, 7
    v_lshlrev_b32 v3, 2, v1
    v_add_u32 v3, 0x24000, v3
    v_add_u32 v4, s56, v3
    s_lshl_b32 s56, s3, 12
    s_add_u32 s56, s56, 0x20000
    v_lshlrev_b32 v5, 4, v1
    v_lshl_add_u32 v5, v2, 10, v5
    v_add_u32 v5, s56, v5
    s_nop 2
    v_max3_f32 v80, v64, v65, v66
    v_max3_f32 v81, v67, v68, v69
    v_max3_f32 v82, v70, v71, v72
    v_max3_f32 v83, v73, v74, v75
    v_max3_f32 v84, v76, v77, v78
    v_max3_f32 v80, v80, v81, v79
    v_max3_f32 v82, v82, v83, v84
    v_max_f32 v80, v80, v82
    v_mov_b32 v81, v80
    s_nop 1
    v_permlane32_swap_b32 v80, v81
    s_nop 1
    v_max_f32 v80, v80, v81
    ds_write_b32 v4, v80
    s_waitcnt lgkmcnt(0)
    s_barrier
    ds_read_b32 v80, v3
    ds_read_b32 v81, v3 offset:128
    ds_read_b32 v82, v3 offset:256
    ds_read_b32 v83, v3 offset:384
    s_waitcnt lgkmcnt(0)
    v_max3_f32 v80, v80, v81, v82
    v_max_f32 v80, v80, v83
    v_sub_f32 v64, v64, v80
    v_sub_f32 v65, v65, v80
    v_sub_f32 v66, v66, v80
    v_sub_f32 v67, v67, v80
    v_sub_f32 v68, v68, v80
    v_sub_f32 v69, v69, v80
    v_sub_f32 v70, v70, v80
    v_sub_f32 v71, v71, v80
    v_exp_f32 v64, v64
    v_exp_f32 v65, v65
    v_exp_f32 v66, v66
    v_exp_f32 v67, v67
    v_exp_f32 v68, v68
    v_exp_f32 v69, v69
    v_exp_f32 v70, v70
    v_exp_f32 v71, v71
    s_nop 0
    v_cvt_pk_bf16_f32 v88, v64, v65
    v_cvt_pk_bf16_f32 v89, v66, v67
    v_cvt_pk_bf16_f32 v90, v68, v69
    v_cvt_pk_bf16_f32 v91, v70, v71
    ds_write_b128 v5, v[88:91] offset:0
    v_sub_f32 v72, v72, v80
    v_sub_f32 v73, v73, v80
    v_sub_f32 v74, v74, v80
    v_sub_f32 v75, v75, v80
    v_sub_f32 v76, v76, v80
    v_sub_f32 v77, v77, v80
    v_sub_f32 v78, v78, v80
    v_sub_f32 v79, v79, v80
    v_exp_f32 v72, v72
    v_exp_f32 v73, v73
    v_exp_f32 v74, v74
    v_exp_f32 v75, v75
    v_exp_f32 v76, v76
    v_exp_f32 v77, v77
    v_exp_f32 v78, v78
    v_exp_f32 v79, v79
    s_nop 0
    v_cvt_pk_bf16_f32 v92, v72, v73
    v_cvt_pk_bf16_f32 v93, v74, v75
    v_cvt_pk_bf16_f32 v94, v76, v77
    v_cvt_pk_bf16_f32 v95, v78, v79
    ds_write_b128 v5, v[92:95] offset:2048
    s_waitcnt lgkmcnt(0)
    s_barrier
    v_add_f32 v64, v64, v72
    v_add_f32 v65, v65, v73
    v_add_f32 v66, v66, v74
    v_add_f32 v67, v67, v75
    v_add_f32 v68, v68, v76
    v_add_f32 v69, v69, v77
    v_add_f32 v70, v70, v78
    v_add_f32 v71, v71, v79
    v_add_f32 v64, v64, v68
    v_add_f32 v65, v65, v69
    v_add_f32 v66, v66, v70
    v_add_f32 v67, v67, v71
    v_add_f32 v64, v64, v66
    v_add_f32 v65, v65, v67
    v_add_f32 v64, v64, v65
    v_mov_b32 v65, v64
    s_lshl_b32 s56, s52, 15
    s_lshl_b32 s57, s53, 7
    v_permlane32_swap_b32 v64, v65
    s_add_u32 s56, s56, s57
    s_lshl_b32 s57, s3, 5
    v_add_f32 v82, v64, v65
    s_add_u32 s56, s56, s57
    s_add_u32 s56, s56, 0x140000
    v_lshrrev_b32 v5, 1, v1
    v_lshlrev_b32 v5, 11, v5
    v_and_b32 v6, 1, v1
    v_lshl_add_u32 v5, v6, 4, v5
    v_mov_b32 v81, s30
    v_mov_b32 v83, s30
    s_waitcnt vmcnt(0)
L_XCHK_4:
    v_cmpx_eq_u32 vcc, s30, v17
    v_cmpx_eq_u32 vcc, s30, v19
    s_cmp_eq_u64 exec, -1
    s_mov_b64 exec, -1
    s_cbranch_scc1 L_XOK_5
    buffer_load_dwordx4 v[16:19], v15, s[32:35], s59 offen sc1
    s_waitcnt vmcnt(0)
    s_add_u32 s31, s31, 1
    s_cmp_lt_u32 s31, 100000
    s_cbranch_scc1 L_XCHK_4
    s_branch L_BAIL
L_XOK_5:
    v_cmp_eq_u32 vcc, s63, v16
    s_cmp_eq_u64 vcc, -1
    s_cbranch_scc0 L_X_STSLOW
    s_mov_b32 exec_hi, 0
    buffer_store_dwordx4 v[80:83], v5, s[32:35], s56 offen
    s_branch L_X_STDONE
L_X_STSLOW:
    s_mov_b32 exec_hi, 0
    buffer_store_dwordx4 v[80:83], v5, s[32:35], s56 offen sc1
L_X_STDONE:
    s_mov_b64 exec, -1
    s_and_b32 s56, s3, 1
    s_lshl_b32 s61, s53, 1
    s_add_u32 s61, s61, s56
    s_lshl_b32 s57, s56, 4
    s_add_u32 s57, s57, s62
L_ST_6:
    buffer_load_dwordx4 v[4:7], v13, s[32:35], s57 offen sc1
    s_waitcnt vmcnt(0)
    v_cmpx_eq_u32 vcc, s30, v5
    v_cmpx_eq_u32 vcc, s30, v7
    s_cmp_eq_u64 exec, -1
    s_mov_b64 exec, -1
    s_cbranch_scc1 L_STOK_7
    s_sleep 1
    s_add_u32 s31, s31, 1
    s_cmp_lt_u32 s31, 100000
    s_cbranch_scc1 L_ST_6
    s_branch L_BAIL
L_STOK_7:
    v_mov_b32 v28, v4
    s_nop 1
    v_max_f32_dpp v28, v28, v28 quad_perm:[1,0,3,2] row_mask:0xf bank_mask:0xf
    s_nop 1
    v_max_f32_dpp v28, v28, v28 quad_perm:[2,3,0,1] row_mask:0xf bank_mask:0xf
    s_nop 1
    v_max_f32_dpp v28, v28, v28 row_half_mirror row_mask:0xf bank_mask:0xf
    s_nop 1
    v_max_f32_dpp v28, v28, v28 row_mirror row_mask:0xf bank_mask:0xf
    v_mov_b32 v9, v28
    s_nop 1
    v_permlane16_swap_b32 v28, v9
    s_nop 1
    v_max_f32 v28, v28, v9
    v_mov_b32 v9, v28
    s_nop 1
    v_permlane32_swap_b32 v28, v9
    s_nop 1
    v_max_f32 v28, v28, v9
    v_sub_f32 v4, v4, v28
    v_exp_f32 v4, v4
    s_nop 0
    v_cvt_pk_bf16_f32 v4, v4, v4
    v_and_b32 v30, 0xffff0000, v4
    v_mul_f32 v30, v30, v6
    v_lshrrev_b32 v2, 4, v0
    v_and_b32 v1, 15, v0
    v_lshlrev_b32 v3, 4, v2
    ds_bpermute_b32 v12, v3, v4 offset:0
    ds_bpermute_b32 v13, v3, v4 offset:64
    ds_bpermute_b32 v14, v3, v4 offset:128
    ds_bpermute_b32 v15, v3, v4 offset:192
    s_nop 1
    v_add_f32_dpp v30, v30, v30 quad_perm:[1,0,3,2] row_mask:0xf bank_mask:0xf
    s_nop 1
    v_add_f32_dpp v30, v30, v30 quad_perm:[2,3,0,1] row_mask:0xf bank_mask:0xf
    s_nop 1
    v_add_f32_dpp v30, v30, v30 row_half_mirror row_mask:0xf bank_mask:0xf
    s_nop 1
    v_add_f32_dpp v30, v30, v30 row_mirror row_mask:0xf bank_mask:0xf
    v_mov_b32 v9, v30
    s_nop 1
    v_permlane16_swap_b32 v30, v9
    s_nop 1
    v_add_f32 v30, v30, v9
    v_mov_b32 v9, v30
    s_nop 1
    v_permlane32_swap_b32 v30, v9
    s_nop 1
    v_add_f32 v30, v30, v9
    v_rcp_f32 v8, v30
    s_cmp_ge_u32 s3, 2
    s_cbranch_scc1 L_X_NOML
    s_lshl_b32 s57, s61, 7
    s_lshl_b32 s58, s52, 4
    s_add_u32 s57, s57, s58
    s_add_u32 s57, s57, 0xc000
    v_mov_b32 v29, s30
    v_mov_b32 v31, s30
    v_mov_b32 v9, 0
    s_mov_b64 exec, 1
    buffer_store_dwordx4 v[28:31], v9, s[32:35], s57 offen sc1
    s_mov_b64 exec, -1
L_X_NOML:
    v_mov_b32 v16, 0xffff
    v_mov_b32 v17, 0xffff0000
    v_and_b32 v18, 1, v1
    v_cmp_eq_u32 vcc, 1, v18
    v_and_b32 v18, 2, v1
    s_nop 0
    v_cndmask_b32 v16, v16, v17, vcc
    v_cmp_eq_u32 vcc, 0, v18
    s_nop 1
    v_cndmask_b32 v10, 0, v16, vcc
    v_cndmask_b32 v11, v16, 0, vcc
    s_waitcnt lgkmcnt(0)
    v_and_b32 v16, v12, v10
    v_and_b32 v17, v12, v11
    v_and_b32 v18, v13, v10
    v_and_b32 v19, v13, v11
    v_and_b32 v20, v14, v10
    v_and_b32 v21, v14, v11
    v_and_b32 v22, v15, v10
    v_and_b32 v23, v15, v11
    v_lshlrev_b32 v3, 2, v0
    v_lshlrev_b32 v5, 11, v2
    v_lshl_add_u32 v5, v1, 4, v5
    s_lshl_b32 s57, s52, 19
    s_lshl_b32 s58, s53, 15
    s_add_u32 s57, s57, s58
    s_lshl_b32 s58, s56, 10
    s_add_u32 s57, s57, s58
    s_lshr_b32 s62, s3, 1
    s_lshl_b32 s58, s62, 9
    s_add_u32 s57, s57, s58
    s_add_u32 s56, s57, 0x400000
    s_add_u32 s57, s56, 8192
    s_add_u32 s58, s56, 16384
    s_add_u32 s59, s56, 24576
    s_lshl_b32 s60, s52, 8
    s_add_u32 s60, s60, 0x8000
    s_lshl_b32 s61, s61, 3
    s_add_u32 s61, s61, s52
    s_lshl_b32 s61, s61, 10
    s_lshl_b32 s62, s62, 9
    s_add_u32 s61, s61, s62
    s_add_u32 s61, s61, 0x200000
    v_lshlrev_b32 v6, 4, v0
    v_mov_b32 v9, v8
L_F1_8:
    buffer_load_dword v4, v3, s[32:35], s60 offen sc1
    s_waitcnt vmcnt(0)
    v_cmp_eq_u32 vcc, s30, v4
    s_cmp_eq_u64 vcc, -1
    s_cbranch_scc1 L_F1OK_9
    s_add_u32 s31, s31, 1
    s_cmp_lt_u32 s31, 100000
    s_cbranch_scc1 L_F1_8
    s_branch L_BAIL
L_F1OK_9:
    buffer_load_dwordx4 v[32:35], v5, s[32:35], s56 offen offset:0 sc1
    buffer_load_dwordx4 v[36:39], v5, s[32:35], s56 offen offset:256 sc1
    buffer_load_dwordx4 v[40:43], v5, s[32:35], s57 offen offset:0 sc1
    buffer_load_dwordx4 v[44:47], v5, s[32:35], s57 offen offset:256 sc1
    buffer_load_dwordx4 v[48:51], v5, s[32:35], s58 offen offset:0 sc1
    buffer_load_dwordx4 v[52:55], v5, s[32:35], s58 offen offset:256 sc1
    buffer_load_dwordx4 v[56:59], v5, s[32:35], s59 offen offset:0 sc1
    buffer_load_dwordx4 v[60:63], v5, s[32:35], s59 offen offset:256 sc1
    s_waitcnt vmcnt(7)
    v_mfma_f32_16x16x16_bf16 v[64:67], v[16:17], v[32:33], 0
    v_mfma_f32_16x16x16_bf16 v[68:71], v[16:17], v[34:35], 0
    s_waitcnt vmcnt(6)
    v_mfma_f32_16x16x16_bf16 v[72:75], v[16:17], v[36:37], 0
    v_mfma_f32_16x16x16_bf16 v[76:79], v[16:17], v[38:39], 0
    s_waitcnt vmcnt(5)
    v_mfma_f32_16x16x16_bf16 v[64:67], v[18:19], v[40:41], v[64:67]
    v_mfma_f32_16x16x16_bf16 v[68:71], v[18:19], v[42:43], v[68:71]
    s_waitcnt vmcnt(4)
    v_mfma_f32_16x16x16_bf16 v[72:75], v[18:19], v[44:45], v[72:75]
    v_mfma_f32_16x16x16_bf16 v[76:79], v[18:19], v[46:47], v[76:79]
    s_waitcnt vmcnt(3)
    v_mfma_f32_16x16x16_bf16 v[64:67], v[20:21], v[48:49], v[64:67]
    v_mfma_f32_16x16x16_bf16 v[68:71], v[20:21], v[50:51], v[68:71]
    s_waitcnt vmcnt(2)
    v_mfma_f32_16x16x16_bf16 v[72:75], v[20:21], v[52:53], v[72:75]
    v_mfma_f32_16x16x16_bf16 v[76:79], v[20:21], v[54:55], v[76:79]
    s_waitcnt vmcnt(1)
    v_mfma_f32_16x16x16_bf16 v[64:67], v[22:23], v[56:57], v[64:67]
    v_mfma_f32_16x16x16_bf16 v[68:71], v[22:23], v[58:59], v[68:71]
    s_waitcnt vmcnt(0)
    v_mfma_f32_16x16x16_bf16 v[72:75], v[22:23], v[60:61], v[72:75]
    v_mfma_f32_16x16x16_bf16 v[76:79], v[22:23], v[62:63], v[76:79]
    s_nop 5
    s_mov_b32 exec_hi, 0
    v_pk_mul_f32 v[24:25], v[64:65], v[8:9]
    v_pk_mul_f32 v[26:27], v[66:67], v[8:9]
    v_pk_mul_f32 v[28:29], v[68:69], v[8:9]
    v_pk_mul_f32 v[30:31], v[70:71], v[8:9]
    s_mov_b32 exec_lo, 0xffff0000
    v_pk_mul_f32 v[24:25], v[72:73], v[8:9]
    v_pk_mul_f32 v[26:27], v[74:75], v[8:9]
    v_pk_mul_f32 v[28:29], v[76:77], v[8:9]
    v_pk_mul_f32 v[30:31], v[78:79], v[8:9]
    s_mov_b32 exec_lo, -1
    v_cvt_pk_bf16_f32 v12, v24, v25
    v_cvt_pk_bf16_f32 v13, v26, v27
    v_cvt_pk_bf16_f32 v14, v28, v29
    v_cvt_pk_bf16_f32 v15, v30, v31
    buffer_store_dwordx4 v[12:15], v6, s[32:35], s61 offen sc1
    s_mov_b64 exec, -1
    s_cmp_ge_u32 s3, 2
    s_cbranch_scc1 L_FIN
    v_lshrrev_b32 v3, 4, v0
    v_lshlrev_b32 v3, 9, v3
    v_and_b32 v4, 7, v0
    v_lshl_add_u32 v3, v4, 5, v3
    v_bfe_u32 v5, v0, 3, 1
    v_lshl_add_u32 v3, v5, 4, v3
    s_lshl_b32 s56, s52, 16
    s_lshl_b32 s57, s53, 12
    s_add_u32 s56, s56, s57
    s_lshl_b32 s57, s3, 8
    s_add_u32 s56, s56, s57
    s_add_u32 s56, s56, 0x280000
    s_lshl_b32 s58, s52, 12
    s_lshl_b32 s59, s53, 8
    s_add_u32 s58, s58, s59
    s_lshl_b32 s59, s3, 7
    s_add_u32 s58, s58, s59
    s_add_u32 s58, s58, 0x240000
    v_lshlrev_b32 v4, 4, v4
    v_lshrrev_b32 v5, 3, v0
    v_lshl_add_u32 v4, v5, 15, v4
L_R1_10:
    buffer_load_dwordx4 v[8:11], v3, s[32:35], s56 offen sc1
    buffer_load_dwordx4 v[12:15], v3, s[32:35], s56 offen offset:2048 sc1
    s_waitcnt vmcnt(0)
    v_cmpx_ne_u32 vcc, -1, v8
    v_cmpx_ne_u32 vcc, -1, v9
    v_cmpx_ne_u32 vcc, -1, v10
    v_cmpx_ne_u32 vcc, -1, v11
    v_cmpx_ne_u32 vcc, -1, v12
    v_cmpx_ne_u32 vcc, -1, v13
    v_cmpx_ne_u32 vcc, -1, v14
    v_cmpx_ne_u32 vcc, -1, v15
    s_cmp_eq_u64 exec, -1
    s_mov_b64 exec, -1
    s_cbranch_scc1 L_R1OK_11
    s_add_u32 s31, s31, 1
    s_cmp_lt_u32 s31, 100000
    s_cbranch_scc1 L_R1_10
    s_branch L_BAIL
L_R1OK_11:
    v_pk_add_f32 v[8:9], v[8:9], v[12:13]
    v_pk_add_f32 v[10:11], v[10:11], v[14:15]
    v_mov_b32 v24, v8
    v_mov_b32 v25, v9
    v_mov_b32 v26, v10
    v_mov_b32 v27, v11
    s_nop 1
    v_permlane16_swap_b32 v8, v24
    v_permlane16_swap_b32 v9, v25
    v_permlane16_swap_b32 v10, v26
    v_permlane16_swap_b32 v11, v27
    s_nop 1
    v_add_f32 v8, v8, v24
    v_add_f32 v9, v9, v25
    v_add_f32 v10, v10, v26
    v_add_f32 v11, v11, v27
    v_mov_b32 v24, v8
    v_mov_b32 v25, v9
    v_mov_b32 v26, v10
    v_mov_b32 v27, v11
    s_nop 1
    v_permlane32_swap_b32 v8, v24
    v_permlane32_swap_b32 v9, v25
    v_permlane32_swap_b32 v10, v26
    v_permlane32_swap_b32 v11, v27
    s_nop 1
    v_add_f32 v8, v8, v24
    v_add_f32 v9, v9, v25
    v_add_f32 v10, v10, v26
    v_add_f32 v11, v11, v27
    v_cvt_pk_bf16_f32 v28, v8, v9
    v_cvt_pk_bf16_f32 v29, v10, v11
    v_cvt_pk_bf16_f32 v30, v8, v9
    v_cvt_pk_bf16_f32 v31, v10, v11
    s_nop 0
    v_mov_b32_dpp v28, v30 row_ror:8 row_mask:0xf bank_mask:0xc
    v_mov_b32_dpp v29, v31 row_ror:8 row_mask:0xf bank_mask:0xc
    v_mov_b32_dpp v30, v30 row_ror:8 row_mask:0xf bank_mask:0x3
    v_mov_b32_dpp v31, v31 row_ror:8 row_mask:0xf bank_mask:0x3
    buffer_store_dwordx4 v[28:31], v4, s[32:35], s58 offen sc1
    s_branch L_FIN
L_X_FINAL:
    s_cmp_ge_u32 s3, 2
    s_cbranch_scc1 L_FIN
    s_lshl_b32 s56, s52, 3
    s_sub_u32 s57, s53, 12
    s_lshl_b32 s57, s57, 1
    s_add_u32 s61, s56, s57
    s_add_u32 s61, s61, s3
    s_mov_b32 s36, s4
    s_and_b32 s37, s5, 0xffff
    s_mov_b32 s38, 0x1000
    s_mov_b32 s39, 0x20000
    s_mov_b32 s40, s24
    s_and_b32 s41, s25, 0xffff
    s_mov_b32 s42, 0x1000
    s_mov_b32 s43, 0x20000
    s_lshr_b32 s56, s61, 1
    s_lshl_b32 s56, s56, 7
    s_add_u32 s56, s56, 0xc000
    v_and_b32 v12, 7, v0
    v_lshlrev_b32 v12, 4, v12
L_GT_12:
    buffer_load_dwordx4 v[8:11], v12, s[32:35], s56 offen sc1
    s_waitcnt vmcnt(0)
    v_cmpx_eq_u32 vcc, s30, v9
    v_cmpx_eq_u32 vcc, s30, v11
    s_cmp_eq_u64 exec, -1
    s_mov_b64 exec, -1
    s_cbranch_scc1 L_GTOK_13
    s_sleep 16
    s_add_u32 s31, s31, 1
    s_cmp_lt_u32 s31, 100000
    s_cbranch_scc1 L_GT_12
    s_branch L_BAIL
L_GTOK_13:
    v_lshrrev_b32 v1, 4, v0
    v_and_b32 v2, 7, v0
    v_lshlrev_b32 v5, 10, v1
    v_lshl_add_u32 v5, v2, 1, v5
    s_lshl_b32 s62, s61, 4
    buffer_load_ushort v40, v5, s[36:39], s62 offen
    v_lshrrev_b32 v3, 3, v0
    v_lshlrev_b32 v3, 12, v3
    v_lshl_add_u32 v3, v2, 3, v3
    s_lshl_b32 s56, s61, 6
    s_lshl_b32 s57, s52, 15
    s_add_u32 s56, s56, s57
    s_add_u32 s56, s56, 0x240000
    v_and_b32 v6, 1, v1
    v_cmp_eq_u32 s[58:59], 1, v6
    v_cmp_lt_u32 s[54:55], 1, v1
L_H_14:
    buffer_load_dwordx2 v[10:11], v3, s[32:35], s56 offen sc1
    s_waitcnt vmcnt(0)
    v_cmpx_ne_u32 vcc, -1, v10
    v_cmpx_ne_u32 vcc, -1, v11
    s_cmp_eq_u64 exec, -1
    s_mov_b64 exec, -1
    s_cbranch_scc1 L_HOK_15
    s_sleep 8
    s_add_u32 s31, s31, 1
    s_cmp_lt_u32 s31, 100000
    s_cbranch_scc1 L_H_14
    s_branch L_BAIL
L_HOK_15:
    v_lshlrev_b32 v8, 16, v10
    v_and_b32 v9, 0xffff0000, v10
    v_lshlrev_b32 v10, 16, v11
    v_and_b32 v11, 0xffff0000, v11
    s_nop 1
    v_add_f32_dpp v8, v8, v8 row_ror:8 row_mask:0xf bank_mask:0xf
    v_add_f32_dpp v9, v9, v9 row_ror:8 row_mask:0xf bank_mask:0xf
    v_add_f32_dpp v10, v10, v10 row_ror:8 row_mask:0xf bank_mask:0xf
    v_add_f32_dpp v11, v11, v11 row_ror:8 row_mask:0xf bank_mask:0xf
    v_mov_b32 v24, v8
    v_mov_b32 v25, v9
    v_mov_b32 v26, v10
    v_mov_b32 v27, v11
    s_nop 1
    v_permlane16_swap_b32 v8, v24
    v_permlane16_swap_b32 v9, v25
    v_permlane16_swap_b32 v10, v26
    v_permlane16_swap_b32 v11, v27
    s_nop 1
    v_add_f32 v8, v8, v24
    v_add_f32 v9, v9, v25
    v_add_f32 v10, v10, v26
    v_add_f32 v11, v11, v27
    v_mov_b32 v24, v8
    v_mov_b32 v25, v9
    v_mov_b32 v26, v10
    v_mov_b32 v27, v11
    s_nop 1
    v_permlane32_swap_b32 v8, v24
    v_permlane32_swap_b32 v9, v25
    v_permlane32_swap_b32 v10, v26
    v_permlane32_swap_b32 v11, v27
    s_nop 1
    v_add_f32 v8, v8, v24
    v_add_f32 v9, v9, v25
    v_add_f32 v10, v10, v26
    v_add_f32 v11, v11, v27
    v_cndmask_b32 v8, v8, v9, s[58:59]
    v_cndmask_b32 v10, v10, v11, s[58:59]
    v_cndmask_b32 v8, v8, v10, s[54:55]
    v_cvt_pk_bf16_f32 v42, v8, v8
    v_and_b32 v42, 0xffff0000, v42
    v_lshlrev_b32 v40, 16, v40
    v_add_f32 v42, v42, v40
    v_cvt_pk_bf16_f32 v42, v42, v42
    v_and_b32 v42, 0xffff0000, v42
    s_lshl_b32 s56, s61, 12
    s_add_u32 s56, s56, 0x340000
    v_lshlrev_b32 v3, 4, v0
    v_and_b32 v4, 0x1ff, v3
    s_and_b32 s57, s61, 15
    s_lshl_b32 s57, s57, 7
    s_add_u32 s57, s57, s56
L_FP_16:
    buffer_load_dwordx4 v[8:11], v3, s[32:35], s56 offen offset:0 sc1
    buffer_load_dwordx4 v[12:15], v3, s[32:35], s56 offen offset:1024 sc1
    buffer_load_dwordx4 v[16:19], v3, s[32:35], s56 offen offset:2048 sc1
    buffer_load_dwordx4 v[20:23], v4, s[32:35], s56 offen offset:3072 sc1
    s_waitcnt vmcnt(0)
    v_cmpx_eq_u32 vcc, s30, v9
    v_cmpx_eq_u32 vcc, s30, v11
    v_cmpx_eq_u32 vcc, s30, v13
    v_cmpx_eq_u32 vcc, s30, v15
    v_cmpx_eq_u32 vcc, s30, v17
    v_cmpx_eq_u32 vcc, s30, v19
    v_cmpx_eq_u32 vcc, s30, v21
    v_cmpx_eq_u32 vcc, s30, v23
    s_cmp_eq_u64 exec, -1
    s_mov_b64 exec, -1
    s_cbranch_scc1 L_FPOK_17
    s_add_u32 s31, s31, 1
    s_cmp_lt_u32 s31, 100000
    s_cbranch_scc1 L_FP_16
    s_branch L_BAIL
L_FPOK_17:
    v_and_b32 v9, 0xffff0000, v8
    v_lshlrev_b32 v8, 16, v8
    v_and_b32 v11, 0xffff0000, v10
    v_lshlrev_b32 v10, 16, v10
    v_and_b32 v13, 0xffff0000, v12
    v_lshlrev_b32 v12, 16, v12
    v_and_b32 v15, 0xffff0000, v14
    v_lshlrev_b32 v14, 16, v14
    v_and_b32 v17, 0xffff0000, v16
    v_lshlrev_b32 v16, 16, v16
    v_and_b32 v19, 0xffff0000, v18
    v_lshlrev_b32 v18, 16, v18
    v_and_b32 v21, 0xffff0000, v20
    v_lshlrev_b32 v20, 16, v20
    v_and_b32 v23, 0xffff0000, v22
    v_lshlrev_b32 v22, 16, v22
    v_pk_add_f32 v[8:9], v[8:9], v[12:13]
    v_pk_add_f32 v[10:11], v[10:11], v[14:15]
    v_pk_add_f32 v[8:9], v[8:9], v[16:17]
    v_pk_add_f32 v[10:11], v[10:11], v[18:19]
    s_mov_b32 exec_hi, 0
    v_pk_add_f32 v[8:9], v[8:9], v[20:21]
    v_pk_add_f32 v[10:11], v[10:11], v[22:23]
    s_mov_b32 exec_hi, -1
    s_nop 0
    v_permlane32_swap_b32 v8, v10
    v_permlane32_swap_b32 v9, v11
    s_nop 1
    v_pk_add_f32 v[8:9], v[8:9], v[10:11]
    s_nop 1
    v_permlane16_swap_b32 v8, v9
    s_nop 1
    v_add_f32 v8, v8, v9
    s_nop 1
    v_add_f32_dpp v8, v8, v8 row_ror:8 row_mask:0xf bank_mask:0xf
    v_cvt_pk_bf16_f32 v8, v8, v8
    v_and_b32 v8, 0xffff0000, v8
    v_add_f32 v8, v8, v42
    v_cvt_pk_bf16_f32 v8, v8, v8
    s_mov_b32 exec_lo, 0x00ff00ff
    s_mov_b32 exec_hi, 0x00ff00ff
    buffer_store_short v8, v5, s[40:43], s62 offen
    s_cmp_lg_u32 s61, 0
    s_cbranch_scc1 L_X_NOEP
    v_mov_b32 v12, s30
    v_mov_b32 v13, 0
    s_mov_b64 exec, 1
    buffer_store_dword v12, v13, s[32:35], 0 offen offset:0 sc1
L_X_NOEP:
    s_mov_b64 exec, -1
    s_branch L_FIN
L_Y_A_DONE:
    s_mov_b32 s36, s6
    s_and_b32 s37, s7, 0xffff
    s_mov_b32 s38, 0x1000000
    s_mov_b32 s39, 0x20000
    s_lshl_b32 s57, s52, 21
    s_lshl_b32 s58, s53, 17
    s_add_u32 s57, s57, s58
    s_lshl_b32 s58, s3, 14
    s_add_u32 s57, s57, s58
    s_add_u32 s57, s57, 12288
    v_lshlrev_b32 v3, 7, v0
    s_cmp_eq_u32 s53, 3
    s_cbranch_scc1 L_Y_NOPF
    s_mov_b32 exec_hi, 0
    buffer_load_dword v247, v3, s[36:39], s57 offen
    s_mov_b64 exec, -1
L_Y_NOPF:
    s_cmp_ge_u32 s53, 8
    s_cbranch_scc1 L_F
    s_lshl_b32 s56, s52, 3
    s_add_u32 s56, s56, s53
    s_lshr_b32 s54, s56, 1
    s_and_b32 s62, s56, 1
    s_mov_b32 s36, s12
    s_and_b32 s37, s13, 0xffff
    s_mov_b32 s38, 0x400000
    s_mov_b32 s39, 0x20000
    s_mov_b32 s40, s14
    s_and_b32 s41, s15, 0xffff
    s_mov_b32 s42, 0x400000
    s_mov_b32 s43, 0x20000
    s_lshl_b32 s59, s54, 8
    s_lshl_b32 s56, s62, 7
    s_add_u32 s59, s59, s56
    v_lshrrev_b32 v3, 3, v0
    s_mov_b32 s56, 8192
    v_mul_lo_u32 v3, v3, s56
    v_and_b32 v4, 7, v0
    v_lshl_add_u32 v3, v4, 4, v3
    s_mul_i32 s57, s3, 524288
    s_add_u32 s57, s57, s59
    s_lshl_b32 s58, s3, 13
    s_add_u32 s58, s58, 24576
    s_mov_b32 m0, s58
    s_add_u32 s58, s58, 1024
    s_waitcnt vmcnt(4)
    buffer_load_dwordx4 v3, s[36:39], s57 offen nt lds
    s_add_u32 s57, s57, 65536
    s_and_b32 s56, s59, 896
    s_cmp_eq_u32 s56, 0x180
    s_cbranch_scc1 L_NT_20
    s_waitcnt vmcnt(0)
L_NT_20:
    s_mov_b32 m0, s58
    s_add_u32 s58, s58, 1024
    s_waitcnt vmcnt(4)
    buffer_load_dwordx4 v3, s[36:39], s57 offen nt lds
    s_add_u32 s57, s57, 65536
    s_and_b32 s56, s59, 896
    s_cmp_eq_u32 s56, 0x180
    s_cbranch_scc1 L_NT_21
    s_waitcnt vmcnt(0)
L_NT_21:
    s_mov_b32 m0, s58
    s_add_u32 s58, s58, 1024
    s_waitcnt vmcnt(4)
    buffer_load_dwordx4 v3, s[36:39], s57 offen nt lds
    s_add_u32 s57, s57, 65536
    s_mov_b32 m0, s58
    s_add_u32 s58, s58, 1024
    s_waitcnt vmcnt(4)
    buffer_load_dwordx4 v3, s[36:39], s57 offen nt lds
    s_add_u32 s57, s57, 65536
    s_mov_b32 m0, s58
    s_add_u32 s58, s58, 1024
    s_waitcnt vmcnt(4)
    buffer_load_dwordx4 v3, s[36:39], s57 offen nt lds
    s_add_u32 s57, s57, 65536
    s_mov_b32 m0, s58
    s_add_u32 s58, s58, 1024
    s_waitcnt vmcnt(4)
    buffer_load_dwordx4 v3, s[36:39], s57 offen nt lds
    s_add_u32 s57, s57, 65536
    s_mov_b32 m0, s58
    s_add_u32 s58, s58, 1024
    s_waitcnt vmcnt(4)
    buffer_load_dwordx4 v3, s[36:39], s57 offen nt lds
    s_add_u32 s57, s57, 65536
    s_mov_b32 m0, s58
    s_add_u32 s58, s58, 1024
    s_waitcnt vmcnt(4)
    buffer_load_dwordx4 v3, s[36:39], s57 offen nt lds
    s_add_u32 s57, s57, 65536
    s_lshl_b32 s59, s54, 17
    s_lshl_b32 s56, s62, 16
    s_add_u32 s59, s59, s56
    v_lshlrev_b32 v3, 4, v0
    s_lshl_b32 s57, s3, 13
    s_add_u32 s57, s57, s59
    s_mul_i32 s58, s3, 8448
    s_add_u32 s58, s58, 90112
    s_mov_b32 m0, s58
    s_add_u32 s58, s58, 1056
    s_waitcnt vmcnt(4)
    buffer_load_dwordx4 v3, s[40:43], s57 offen nt lds
    s_add_u32 s57, s57, 1024
    s_mov_b32 m0, s58
    s_add_u32 s58, s58, 1056
    s_waitcnt vmcnt(4)
    buffer_load_dwordx4 v3, s[40:43], s57 offen nt lds
    s_add_u32 s57, s57, 1024
    s_mov_b32 m0, s58
    s_add_u32 s58, s58, 1056
    s_waitcnt vmcnt(4)
    buffer_load_dwordx4 v3, s[40:43], s57 offen nt lds
    s_add_u32 s57, s57, 1024
    s_mov_b32 m0, s58
    s_add_u32 s58, s58, 1056
    s_waitcnt vmcnt(4)
    buffer_load_dwordx4 v3, s[40:43], s57 offen nt lds
    s_add_u32 s57, s57, 1024
    s_mov_b32 m0, s58
    s_add_u32 s58, s58, 1056
    s_waitcnt vmcnt(4)
    buffer_load_dwordx4 v3, s[40:43], s57 offen nt lds
    s_add_u32 s57, s57, 1024
    s_mov_b32 m0, s58
    s_add_u32 s58, s58, 1056
    s_waitcnt vmcnt(4)
    buffer_load_dwordx4 v3, s[40:43], s57 offen nt lds
    s_add_u32 s57, s57, 1024
    s_mov_b32 m0, s58
    s_add_u32 s58, s58, 1056
    s_waitcnt vmcnt(4)
    buffer_load_dwordx4 v3, s[40:43], s57 offen nt lds
    s_add_u32 s57, s57, 1024
    s_mov_b32 m0, s58
    s_add_u32 s58, s58, 1056
    s_waitcnt vmcnt(4)
    buffer_load_dwordx4 v3, s[40:43], s57 offen nt lds
    s_add_u32 s57, s57, 1024
    s_waitcnt vmcnt(5)
    s_barrier
    s_cmp_ge_u32 s3, 4
    s_cbranch_scc1 L_C_NOW1
    v_lshrrev_b32 v3, 4, v0
    v_bfe_u32 v4, v0, 2, 2
    v_lshl_add_u32 v3, v3, 3, v4
    v_lshlrev_b32 v3, 7, v3
    v_and_b32 v4, 3, v0
    v_lshl_add_u32 v3, v4, 3, v3
    s_lshl_b32 s56, s3, 5
    s_add_u32 s56, s56, 24576
    v_add_u32 v3, s56, v3
    ds_read_b64_tr_b16 v[96:97], v3 offset:0
    ds_read_b64_tr_b16 v[98:99], v3 offset:512
    ds_read_b64_tr_b16 v[100:101], v3 offset:4096
    ds_read_b64_tr_b16 v[102:103], v3 offset:4608
    ds_read_b64_tr_b16 v[104:105], v3 offset:8192
    ds_read_b64_tr_b16 v[106:107], v3 offset:8704
    ds_read_b64_tr_b16 v[108:109], v3 offset:12288
    ds_read_b64_tr_b16 v[110:111], v3 offset:12800
    s_waitcnt lgkmcnt(0)
    ds_read_b64_tr_b16 v[112:113], v3 offset:16384
    ds_read_b64_tr_b16 v[114:115], v3 offset:16896
    ds_read_b64_tr_b16 v[116:117], v3 offset:20480
    ds_read_b64_tr_b16 v[118:119], v3 offset:20992
    ds_read_b64_tr_b16 v[120:121], v3 offset:24576
    ds_read_b64_tr_b16 v[122:123], v3 offset:25088
    ds_read_b64_tr_b16 v[124:125], v3 offset:28672
    ds_read_b64_tr_b16 v[126:127], v3 offset:29184
    s_waitcnt lgkmcnt(0)
    ds_read_b64_tr_b16 v[128:129], v3 offset:32768
    ds_read_b64_tr_b16 v[130:131], v3 offset:33280
    ds_read_b64_tr_b16 v[132:133], v3 offset:36864
    ds_read_b64_tr_b16 v[134:135], v3 offset:37376
    ds_read_b64_tr_b16 v[136:137], v3 offset:40960
    ds_read_b64_tr_b16 v[138:139], v3 offset:41472
    ds_read_b64_tr_b16 v[140:141], v3 offset:45056
    ds_read_b64_tr_b16 v[142:143], v3 offset:45568
    s_waitcnt lgkmcnt(0)
    ds_read_b64_tr_b16 v[144:145], v3 offset:49152
    ds_read_b64_tr_b16 v[146:147], v3 offset:49664
    ds_read_b64_tr_b16 v[148:149], v3 offset:53248
    ds_read_b64_tr_b16 v[150:151], v3 offset:53760
    ds_read_b64_tr_b16 v[152:153], v3 offset:57344
    ds_read_b64_tr_b16 v[154:155], v3 offset:57856
    ds_read_b64_tr_b16 v[156:157], v3 offset:61440
    ds_read_b64_tr_b16 v[158:159], v3 offset:61952
    s_waitcnt lgkmcnt(0)
L_C_NOW1:
    s_and_b32 s56, s2, 7
    s_lshl_b32 s56, s56, 9
    s_add_u32 s56, s56, 0x1000
    v_and_b32 v8, 31, v0
    v_lshlrev_b32 v8, 4, v8
L_XID_22:
    buffer_load_dwordx4 v[4:7], v8, s[32:35], s56 offen sc1
    s_waitcnt vmcnt(0)
    v_cmpx_eq_u32 vcc, s30, v5
    v_cmpx_eq_u32 vcc, s30, v7
    s_cmp_eq_u64 exec, -1
    s_mov_b64 exec, -1
    s_cbranch_scc1 L_XIDOK_23
    s_add_u32 s31, s31, 1
    s_cmp_lt_u32 s31, 100000
    s_cbranch_scc1 L_XID_22
    s_branch L_BAIL
L_XIDOK_23:
    v_cmp_eq_u32 vcc, s63, v4
    s_cmp_eq_u64 vcc, -1
    s_cselect_b32 s55, 1, 0
    s_barrier
    v_lshrrev_b32 v3, 4, v0
    v_bfe_u32 v4, v0, 2, 2
    v_lshl_add_u32 v3, v3, 3, v4
    s_movk_i32 s56, 1056
    v_mul_lo_u32 v3, v3, s56
    v_and_b32 v4, 3, v0
    v_lshl_add_u32 v3, v4, 3, v3
    s_lshl_b32 s56, s3, 7
    s_add_u32 s56, s56, 90112
    v_add_u32 v3, s56, v3
    ds_read_b64_tr_b16 v[64:65], v3 offset:0
    ds_read_b64_tr_b16 v[66:67], v3 offset:4224
    ds_read_b64_tr_b16 v[68:69], v3 offset:33792
    ds_read_b64_tr_b16 v[70:71], v3 offset:38016
    ds_read_b64_tr_b16 v[72:73], v3 offset:32
    ds_read_b64_tr_b16 v[74:75], v3 offset:4256
    ds_read_b64_tr_b16 v[76:77], v3 offset:33824
    ds_read_b64_tr_b16 v[78:79], v3 offset:38048
    s_waitcnt lgkmcnt(0)
    ds_read_b64_tr_b16 v[80:81], v3 offset:64
    ds_read_b64_tr_b16 v[82:83], v3 offset:4288
    ds_read_b64_tr_b16 v[84:85], v3 offset:33856
    ds_read_b64_tr_b16 v[86:87], v3 offset:38080
    ds_read_b64_tr_b16 v[88:89], v3 offset:96
    ds_read_b64_tr_b16 v[90:91], v3 offset:4320
    ds_read_b64_tr_b16 v[92:93], v3 offset:33888
    ds_read_b64_tr_b16 v[94:95], v3 offset:38112
    s_waitcnt lgkmcnt(0)
    v_lshrrev_b32 v41, 5, v0
    v_lshlrev_b32 v41, 12, v41
    v_and_b32 v4, 31, v0
    v_lshl_add_u32 v41, v4, 4, v41
    s_lshl_b32 s61, s52, 16
    s_lshl_b32 s57, s3, 13
    s_add_u32 s61, s61, s57
    s_lshl_b32 s57, s53, 9
    s_add_u32 s61, s61, s57
    s_add_u32 s61, s61, 0x280000
    s_lshl_b32 s56, s54, 13
    s_lshl_b32 s57, s3, 10
    s_add_u32 s56, s56, s57
    s_add_u32 s56, s56, 0x200000
    v_lshlrev_b32 v3, 4, v0
    v_mov_b32 v4, v3
    s_mul_i32 s57, s3, 1040
    s_add_u32 s57, s57, 0
    v_add_u32 v4, s57, v4
    v_and_b32 v5, 7, v0
    s_movk_i32 s57, 1040
    v_mul_lo_u32 v5, v5, s57
    v_lshrrev_b32 v6, 4, v0
    v_lshl_add_u32 v5, v6, 4, v5
    v_add_u32 v5, 0, v5
    v_bfe_u32 v7, v0, 1, 2
    s_movk_i32 s57, 144
    v_mul_lo_u32 v7, v7, s57
    v_lshl_add_u32 v7, v6, 3, v7
    s_lshl_b32 s58, s3, 5
    v_add_u32 v7, s58, v7
    v_and_b32 v2, 3, v0
    v_mul_lo_u32 v2, v2, s57
    v_lshl_add_u32 v2, v6, 4, v2
    s_lshl_b32 s58, s54, 7
    s_add_u32 s58, s58, 0xc000
    v_and_b32 v40, 7, v0
    v_lshlrev_b32 v40, 4, v40
L_C_ML:
    buffer_load_dwordx4 v[8:11], v40, s[32:35], s58 offen sc1
    s_waitcnt vmcnt(0)
    v_cmpx_eq_u32 vcc, s30, v9
    v_cmpx_eq_u32 vcc, s30, v11
    s_cmp_eq_u64 exec, -1
    s_mov_b64 exec, -1
    s_cbranch_scc1 L_C_MLOK
    s_sleep 4
    s_add_u32 s31, s31, 1
    s_cmp_lt_u32 s31, 100000
    s_cbranch_scc1 L_C_ML
    s_branch L_BAIL
L_C_MLOK:
    s_nop 4
    v_max_f32_dpp v12, v8, v8 quad_perm:[1,0,3,2] row_mask:0xf bank_mask:0xf
    v_sub_f32 v8, v8, v12
    v_exp_f32 v8, v8
    s_nop 0
    v_mul_f32 v8, v8, v10
    s_nop 1
    v_add_f32_dpp v12, v8, v8 quad_perm:[1,0,3,2] row_mask:0xf bank_mask:0xf
    v_rcp_f32 v12, v12
    s_nop 0
    v_mul_f32 v40, v8, v12
L_C_SEN:
L_O2_24:
    buffer_load_dwordx4 v[8:11], v3, s[32:35], s56 offen sc1
    s_waitcnt vmcnt(0)
    v_cmpx_ne_u32 vcc, -1, v8
    v_cmpx_ne_u32 vcc, -1, v9
    v_cmpx_ne_u32 vcc, -1, v10
    v_cmpx_ne_u32 vcc, -1, v11
    s_cmp_eq_u64 exec, -1
    s_mov_b64 exec, -1
    s_cbranch_scc1 L_O2OK_25
    s_add_u32 s31, s31, 1
    s_cmp_lt_u32 s31, 100000
    s_cbranch_scc1 L_O2_24
    s_branch L_BAIL
L_O2OK_25:
    ds_write_b128 v4, v[8:11]
    s_waitcnt lgkmcnt(0)
    s_barrier
    s_cmp_ge_u32 s3, 4
    s_cbranch_scc1 L_C_G2
    ds_read_b128 v[16:19], v5 offset:0
    ds_read_b128 v[20:23], v5 offset:64
    ds_read_b128 v[24:27], v5 offset:128
    ds_read_b128 v[28:31], v5 offset:192
    s_waitcnt lgkmcnt(3)
    v_mfma_f32_16x16x32_bf16 v[32:35], v[96:99], v[16:19], 0
    ds_read_b128 v[16:19], v5 offset:256
    s_waitcnt lgkmcnt(3)
    v_mfma_f32_16x16x32_bf16 v[32:35], v[100:103], v[20:23], v[32:35]
    ds_read_b128 v[20:23], v5 offset:320
    s_waitcnt lgkmcnt(3)
    v_mfma_f32_16x16x32_bf16 v[32:35], v[104:107], v[24:27], v[32:35]
    ds_read_b128 v[24:27], v5 offset:384
    s_waitcnt lgkmcnt(3)
    v_mfma_f32_16x16x32_bf16 v[32:35], v[108:111], v[28:31], v[32:35]
    ds_read_b128 v[28:31], v5 offset:448
    s_waitcnt lgkmcnt(3)
    v_mfma_f32_16x16x32_bf16 v[32:35], v[112:115], v[16:19], v[32:35]
    ds_read_b128 v[16:19], v5 offset:512
    s_waitcnt lgkmcnt(3)
    v_mfma_f32_16x16x32_bf16 v[32:35], v[116:119], v[20:23], v[32:35]
    ds_read_b128 v[20:23], v5 offset:576
    s_waitcnt lgkmcnt(3)
    v_mfma_f32_16x16x32_bf16 v[32:35], v[120:123], v[24:27], v[32:35]
    ds_read_b128 v[24:27], v5 offset:640
    s_waitcnt lgkmcnt(3)
    v_mfma_f32_16x16x32_bf16 v[32:35], v[124:127], v[28:31], v[32:35]
    ds_read_b128 v[28:31], v5 offset:704
    s_waitcnt lgkmcnt(3)
    v_mfma_f32_16x16x32_bf16 v[32:35], v[128:131], v[16:19], v[32:35]
    ds_read_b128 v[16:19], v5 offset:768
    s_waitcnt lgkmcnt(3)
    v_mfma_f32_16x16x32_bf16 v[32:35], v[132:135], v[20:23], v[32:35]
    ds_read_b128 v[20:23], v5 offset:832
    s_waitcnt lgkmcnt(3)
    v_mfma_f32_16x16x32_bf16 v[32:35], v[136:139], v[24:27], v[32:35]
    ds_read_b128 v[24:27], v5 offset:896
    s_waitcnt lgkmcnt(3)
    v_mfma_f32_16x16x32_bf16 v[32:35], v[140:143], v[28:31], v[32:35]
    ds_read_b128 v[28:31], v5 offset:960
    s_waitcnt lgkmcnt(3)
    v_mfma_f32_16x16x32_bf16 v[32:35], v[144:147], v[16:19], v[32:35]
    s_waitcnt lgkmcnt(2)
    v_mfma_f32_16x16x32_bf16 v[32:35], v[148:151], v[20:23], v[32:35]
    s_waitcnt lgkmcnt(1)
    v_mfma_f32_16x16x32_bf16 v[32:35], v[152:155], v[24:27], v[32:35]
    s_waitcnt lgkmcnt(0)
    v_mfma_f32_16x16x32_bf16 v[32:35], v[156:159], v[28:31], v[32:35]
    s_nop 7
    v_mul_f32 v32, v32, v40
    v_mul_f32 v33, v33, v40
    v_mul_f32 v34, v34, v40
    v_mul_f32 v35, v35, v40
    v_add_f32_dpp v36, v32, v32 quad_perm:[1,0,3,2] row_mask:0xf bank_mask:0xf
    v_add_f32_dpp v37, v33, v33 quad_perm:[1,0,3,2] row_mask:0xf bank_mask:0xf
    v_add_f32_dpp v38, v34, v34 quad_perm:[1,0,3,2] row_mask:0xf bank_mask:0xf
    v_add_f32_dpp v39, v35, v35 quad_perm:[1,0,3,2] row_mask:0xf bank_mask:0xf
    v_cvt_pk_bf16_f32 v36, v36, v37
    v_cvt_pk_bf16_f32 v37, v38, v39
    s_mov_b32 exec_lo, 0x00550055
    s_mov_b32 exec_hi, 0x00550055
    ds_write_b64 v7, v[36:37] offset:9216
    s_mov_b64 exec, -1
    s_waitcnt lgkmcnt(0)
L_C_G2:
    s_barrier
    ds_read_b128 v[16:19], v2 offset:9216
    ds_read_b128 v[20:23], v2 offset:9280
    s_waitcnt lgkmcnt(1)
    v_mfma_f32_16x16x32_bf16 v[24:27], v[16:19], v[64:67], 0
    v_mfma_f32_16x16x32_bf16 v[28:31], v[16:19], v[72:75], 0
    v_mfma_f32_16x16x32_bf16 v[32:35], v[16:19], v[80:83], 0
    v_mfma_f32_16x16x32_bf16 v[36:39], v[16:19], v[88:91], 0
    s_waitcnt lgkmcnt(0)
    v_mfma_f32_16x16x32_bf16 v[24:27], v[20:23], v[68:71], v[24:27]
    v_mfma_f32_16x16x32_bf16 v[28:31], v[20:23], v[76:79], v[28:31]
    v_mfma_f32_16x16x32_bf16 v[32:35], v[20:23], v[84:87], v[32:35]
    v_mfma_f32_16x16x32_bf16 v[36:39], v[20:23], v[92:95], v[36:39]
    s_nop 4
    v_mov_b32 v8, v24
    v_mov_b32 v9, v25
    v_mov_b32 v10, v26
    v_mov_b32 v11, v27
    s_mov_b32 exec_lo, 0xffff0000
    v_mov_b32 v8, v28
    v_mov_b32 v9, v29
    v_mov_b32 v10, v30
    v_mov_b32 v11, v31
    s_mov_b32 exec_lo, 0
    v_mov_b32 v8, v32
    v_mov_b32 v9, v33
    v_mov_b32 v10, v34
    v_mov_b32 v11, v35
    s_mov_b32 exec_hi, 0xffff0000
    v_mov_b32 v8, v36
    v_mov_b32 v9, v37
    v_mov_b32 v10, v38
    v_mov_b32 v11, v39
    s_mov_b64 exec, -1
    s_cmp_eq_u32 s55, 0
    s_cbranch_scc1 L_C_SLOW
    buffer_store_dwordx4 v[8:11], v41, s[32:35], s61 offen
    s_branch L_C_DONE
L_C_SLOW:
    buffer_store_dwordx4 v[8:11], v41, s[32:35], s61 offen sc1
L_C_DONE:
    s_branch L_FIN
L_F:
    s_cmp_lt_u32 s53, 12
    s_cbranch_scc1 L_F2
    s_sub_u32 s56, s53, 12
    s_lshl_b32 s57, s52, 19
    s_lshl_b32 s58, s56, 17
    s_add_u32 s57, s57, s58
    s_lshl_b32 s58, s3, 14
    s_add_u32 s57, s57, s58
    s_add_u32 s57, s57, 0x400000
    s_add_u32 s58, s57, 8192
    v_lshlrev_b32 v1, 7, v0
    s_lshl_b32 s59, s52, 15
    s_lshl_b32 s60, s56, 13
    s_add_u32 s59, s59, s60
    s_add_u32 s59, s59, 0x140000
    s_cmp_lg_u32 s3, 0
    s_cbranch_scc1 L_H1
    buffer_load_dword v10, v1, s[32:35], s59 offen
L_H1:
    s_cmp_lg_u32 s3, 1
    s_cbranch_scc1 L_H2
    s_lshl_b32 s59, s52, 8
    s_add_u32 s59, s59, 0x8000
    v_lshlrev_b32 v2, 2, v0
    buffer_load_dword v10, v2, s[32:35], s59 offen
L_H2:
    s_cmp_lt_u32 s3, 6
    s_cbranch_scc1 L_H3
    s_lshl_b32 s59, s52, 16
    s_lshl_b32 s60, s56, 14
    s_add_u32 s59, s59, s60
    s_lshl_b32 s60, s3, 13
    s_add_u32 s59, s59, s60
    s_add_u32 s59, s59, 0x274000
    buffer_load_dword v10, v1, s[32:35], s59 offen
L_H3:
    s_mov_b32 s40, s14
    s_and_b32 s41, s15, 0xffff
    s_mov_b32 s42, 0x400000
    s_mov_b32 s43, 0x20000
    v_lshrrev_b32 v1, 3, v0
    v_lshlrev_b32 v1, 13, v1
    v_and_b32 v2, 7, v0
    v_lshl_add_u32 v1, v2, 7, v1
    s_lshl_b32 s57, s52, 19
    s_lshl_b32 s58, s56, 17
    s_add_u32 s57, s57, s58
    s_lshl_b32 s58, s3, 10
    s_add_u32 s57, s57, s58
    s_add_u32 s59, s57, 0x10000
    buffer_load_dword v11, v1, s[40:43], s57 offen
    buffer_load_dword v12, v1, s[40:43], s59 offen
    s_mov_b32 s44, s22
    s_and_b32 s45, s23, 0xffff
    s_mov_b32 s46, 0x1c0000
    s_mov_b32 s47, 0x20000
    s_lshl_b32 s57, s56, 3
    s_add_u32 s57, s57, s52
    s_lshl_b32 s57, s57, 16
    s_add_u32 s57, s57, s58
    buffer_load_dword v13, v1, s[44:47], s57 offen
    s_waitcnt vmcnt(0)
    s_branch L_X_FINAL
L_F2:
    s_sub_u32 s56, s53, 8
    s_lshl_b32 s54, s56, 3
    s_add_u32 s54, s54, s52
    s_cmp_ge_u32 s54, 28
    s_cbranch_scc1 L_FIN
    s_mov_b32 s36, s18
    s_and_b32 s37, s19, 0xffff
    s_mov_b32 s38, 0x1c0000
    s_mov_b32 s39, 0x20000
    s_mov_b32 s40, s20
    s_and_b32 s41, s21, 0xffff
    s_mov_b32 s42, 0x1c0000
    s_mov_b32 s43, 0x20000
    s_mov_b32 s44, s22
    s_and_b32 s45, s23, 0xffff
    s_mov_b32 s46, 0x1c0000
    s_mov_b32 s47, 0x20000
    s_mov_b32 s48, s4
    s_and_b32 s49, s5, 0xffff
    s_mov_b32 s50, 0x1000
    s_mov_b32 s51, 0x20000
    s_lshl_b32 s56, s3, 7
    v_lshlrev_b32 v3, 1, v0
    buffer_load_ushort v40, v3, s[48:51], s56 offen
    buffer_load_ushort v41, v3, s[48:51], s56 offen offset:1024
    buffer_load_ushort v42, v3, s[48:51], s56 offen offset:2048
    buffer_load_ushort v43, v3, s[48:51], s56 offen offset:3072
    v_add_u32 v44, s56, v3
    v_add_u32 v44, 0, v44
    v_mov_b32 v4, 0x3f80
    ds_write_b16 v44, v4 offset:4160
    s_lshl_b32 s59, s54, 7
    v_lshrrev_b32 v3, 3, v0
    s_mov_b32 s56, 3584
    v_mul_lo_u32 v3, v3, s56
    v_and_b32 v4, 7, v0
    v_lshl_add_u32 v3, v4, 4, v3
    s_mul_i32 s57, s3, 229376
    s_add_u32 s57, s57, s59
    s_lshl_b32 s58, s3, 13
    s_add_u32 s58, s58, 24576
    s_mov_b32 m0, s58
    s_add_u32 s58, s58, 1024
    s_waitcnt vmcnt(4)
    buffer_load_dwordx4 v3, s[36:39], s57 offen nt lds
    s_add_u32 s57, s57, 28672
    s_and_b32 s56, s59, 384
    s_cmp_eq_u32 s56, 0x180
    s_cbranch_scc1 L_NT_26
    s_waitcnt vmcnt(0)
L_NT_26:
    s_mov_b32 m0, s58
    s_add_u32 s58, s58, 1024
    s_waitcnt vmcnt(4)
    buffer_load_dwordx4 v3, s[36:39], s57 offen nt lds
    s_add_u32 s57, s57, 28672
    s_and_b32 s56, s59, 384
    s_cmp_eq_u32 s56, 0x180
    s_cbranch_scc1 L_NT_27
    s_waitcnt vmcnt(0)
L_NT_27:
    s_mov_b32 m0, s58
    s_add_u32 s58, s58, 1024
    s_waitcnt vmcnt(4)
    buffer_load_dwordx4 v3, s[36:39], s57 offen nt lds
    s_add_u32 s57, s57, 28672
    s_mov_b32 m0, s58
    s_add_u32 s58, s58, 1024
    s_waitcnt vmcnt(4)
    buffer_load_dwordx4 v3, s[36:39], s57 offen nt lds
    s_add_u32 s57, s57, 28672
    s_mov_b32 m0, s58
    s_add_u32 s58, s58, 1024
    s_waitcnt vmcnt(4)
    buffer_load_dwordx4 v3, s[36:39], s57 offen nt lds
    s_add_u32 s57, s57, 28672
    s_mov_b32 m0, s58
    s_add_u32 s58, s58, 1024
    s_waitcnt vmcnt(4)
    buffer_load_dwordx4 v3, s[36:39], s57 offen nt lds
    s_add_u32 s57, s57, 28672
    s_mov_b32 m0, s58
    s_add_u32 s58, s58, 1024
    s_waitcnt vmcnt(4)
    buffer_load_dwordx4 v3, s[36:39], s57 offen nt lds
    s_add_u32 s57, s57, 28672
    s_mov_b32 m0, s58
    s_add_u32 s58, s58, 1024
    s_waitcnt vmcnt(4)
    buffer_load_dwordx4 v3, s[36:39], s57 offen nt lds
    s_add_u32 s57, s57, 28672
    v_lshrrev_b32 v3, 3, v0
    s_mov_b32 s56, 3584
    v_mul_lo_u32 v3, v3, s56
    v_and_b32 v4, 7, v0
    v_lshl_add_u32 v3, v4, 4, v3
    s_mul_i32 s57, s3, 229376
    s_add_u32 s57, s57, s59
    s_lshl_b32 s58, s3, 13
    s_add_u32 s58, s58, 90112
    s_mov_b32 m0, s58
    s_add_u32 s58, s58, 1024
    s_waitcnt vmcnt(4)
    buffer_load_dwordx4 v3, s[40:43], s57 offen nt lds
    s_add_u32 s57, s57, 28672
    s_mov_b32 m0, s58
    s_add_u32 s58, s58, 1024
    s_waitcnt vmcnt(4)
    buffer_load_dwordx4 v3, s[40:43], s57 offen nt lds
    s_add_u32 s57, s57, 28672
    s_mov_b32 m0, s58
    s_add_u32 s58, s58, 1024
    s_waitcnt vmcnt(4)
    buffer_load_dwordx4 v3, s[40:43], s57 offen nt lds
    s_add_u32 s57, s57, 28672
    s_mov_b32 m0, s58
    s_add_u32 s58, s58, 1024
    s_waitcnt vmcnt(4)
    buffer_load_dwordx4 v3, s[40:43], s57 offen nt lds
    s_add_u32 s57, s57, 28672
    s_mov_b32 m0, s58
    s_add_u32 s58, s58, 1024
    s_waitcnt vmcnt(4)
    buffer_load_dwordx4 v3, s[40:43], s57 offen nt lds
    s_add_u32 s57, s57, 28672
    s_mov_b32 m0, s58
    s_add_u32 s58, s58, 1024
    s_waitcnt vmcnt(4)
    buffer_load_dwordx4 v3, s[40:43], s57 offen nt lds
    s_add_u32 s57, s57, 28672
    s_mov_b32 m0, s58
    s_add_u32 s58, s58, 1024
    s_waitcnt vmcnt(4)
    buffer_load_dwordx4 v3, s[40:43], s57 offen nt lds
    s_add_u32 s57, s57, 28672
    s_mov_b32 m0, s58
    s_add_u32 s58, s58, 1024
    s_waitcnt vmcnt(4)
    buffer_load_dwordx4 v3, s[40:43], s57 offen nt lds
    s_add_u32 s57, s57, 28672
    s_barrier
    v_lshlrev_b32 v45, 4, v0
    s_lshl_b32 s57, s54, 16
    s_lshl_b32 s58, s3, 13
    s_add_u32 s57, s57, s58
    s_add_u32 s58, s57, 4096
    s_waitcnt vmcnt(4)
    buffer_load_dwordx4 v[64:67], v45, s[44:47], s57 offen offset:0 nt
    s_waitcnt vmcnt(4)
    buffer_load_dwordx4 v[68:71], v45, s[44:47], s57 offen offset:1024 nt
    s_waitcnt vmcnt(4)
    buffer_load_dwordx4 v[72:75], v45, s[44:47], s57 offen offset:2048 nt
    s_waitcnt vmcnt(4)
    buffer_load_dwordx4 v[76:79], v45, s[44:47], s57 offen offset:3072 nt
    s_waitcnt vmcnt(4)
    buffer_load_dwordx4 v[80:83], v45, s[44:47], s58 offen offset:0 nt
    s_waitcnt vmcnt(4)
    buffer_load_dwordx4 v[84:87], v45, s[44:47], s58 offen offset:1024 nt
    s_waitcnt vmcnt(4)
    buffer_load_dwordx4 v[88:91], v45, s[44:47], s58 offen offset:2048 nt
    s_waitcnt vmcnt(4)
    buffer_load_dwordx4 v[92:95], v45, s[44:47], s58 offen offset:3072 nt
    s_cmp_ge_u32 s3, 4
    s_cbranch_scc1 L_F_NOW1a
    v_lshrrev_b32 v3, 4, v0
    v_bfe_u32 v4, v0, 2, 2
    v_lshl_add_u32 v3, v3, 3, v4
    v_lshlrev_b32 v3, 7, v3
    v_and_b32 v4, 3, v0
    v_lshl_add_u32 v3, v4, 3, v3
    s_lshl_b32 s56, s3, 5
    s_add_u32 s56, s56, 24576
    v_add_u32 v3, s56, v3
    ds_read_b64_tr_b16 v[96:97], v3 offset:0
    ds_read_b64_tr_b16 v[98:99], v3 offset:512
    ds_read_b64_tr_b16 v[100:101], v3 offset:4096
    ds_read_b64_tr_b16 v[102:103], v3 offset:4608
    ds_read_b64_tr_b16 v[104:105], v3 offset:8192
    ds_read_b64_tr_b16 v[106:107], v3 offset:8704
    ds_read_b64_tr_b16 v[108:109], v3 offset:12288
    ds_read_b64_tr_b16 v[110:111], v3 offset:12800
    s_waitcnt lgkmcnt(0)
    ds_read_b64_tr_b16 v[112:113], v3 offset:16384
    ds_read_b64_tr_b16 v[114:115], v3 offset:16896
    ds_read_b64_tr_b16 v[116:117], v3 offset:20480
    ds_read_b64_tr_b16 v[118:119], v3 offset:20992
    ds_read_b64_tr_b16 v[120:121], v3 offset:24576
    ds_read_b64_tr_b16 v[122:123], v3 offset:25088
    ds_read_b64_tr_b16 v[124:125], v3 offset:28672
    ds_read_b64_tr_b16 v[126:127], v3 offset:29184
    s_waitcnt lgkmcnt(0)
    ds_read_b64_tr_b16 v[128:129], v3 offset:32768
    ds_read_b64_tr_b16 v[130:131], v3 offset:33280
    ds_read_b64_tr_b16 v[132:133], v3 offset:36864
    ds_read_b64_tr_b16 v[134:135], v3 offset:37376
    ds_read_b64_tr_b16 v[136:137], v3 offset:40960
    ds_read_b64_tr_b16 v[138:139], v3 offset:41472
    ds_read_b64_tr_b16 v[140:141], v3 offset:45056
    ds_read_b64_tr_b16 v[142:143], v3 offset:45568
    s_waitcnt lgkmcnt(0)
    ds_read_b64_tr_b16 v[144:145], v3 offset:49152
    ds_read_b64_tr_b16 v[146:147], v3 offset:49664
    ds_read_b64_tr_b16 v[148:149], v3 offset:53248
    ds_read_b64_tr_b16 v[150:151], v3 offset:53760
    ds_read_b64_tr_b16 v[152:153], v3 offset:57344
    ds_read_b64_tr_b16 v[154:155], v3 offset:57856
    ds_read_b64_tr_b16 v[156:157], v3 offset:61440
    ds_read_b64_tr_b16 v[158:159], v3 offset:61952
    s_waitcnt lgkmcnt(0)
L_F_NOW1a:
    s_barrier
    s_cmp_ge_u32 s3, 4
    s_cbranch_scc1 L_F_NOW1
    v_lshrrev_b32 v3, 4, v0
    v_bfe_u32 v4, v0, 2, 2
    v_lshl_add_u32 v3, v3, 3, v4
    v_lshlrev_b32 v3, 7, v3
    v_and_b32 v4, 3, v0
    v_lshl_add_u32 v3, v4, 3, v3
    s_lshl_b32 s56, s3, 5
    s_add_u32 s56, s56, 90112
    v_add_u32 v3, s56, v3
    ds_read_b64_tr_b16 v[160:161], v3 offset:0
    ds_read_b64_tr_b16 v[162:163], v3 offset:512
    ds_read_b64_tr_b16 v[164:165], v3 offset:4096
    ds_read_b64_tr_b16 v[166:167], v3 offset:4608
    ds_read_b64_tr_b16 v[168:169], v3 offset:8192
    ds_read_b64_tr_b16 v[170:171], v3 offset:8704
    ds_read_b64_tr_b16 v[172:173], v3 offset:12288
    ds_read_b64_tr_b16 v[174:175], v3 offset:12800
    s_waitcnt lgkmcnt(0)
    ds_read_b64_tr_b16 v[176:177], v3 offset:16384
    ds_read_b64_tr_b16 v[178:179], v3 offset:16896
    ds_read_b64_tr_b16 v[180:181], v3 offset:20480
    ds_read_b64_tr_b16 v[182:183], v3 offset:20992
    ds_read_b64_tr_b16 v[184:185], v3 offset:24576
    ds_read_b64_tr_b16 v[186:187], v3 offset:25088
    ds_read_b64_tr_b16 v[188:189], v3 offset:28672
    ds_read_b64_tr_b16 v[190:191], v3 offset:29184
    s_waitcnt lgkmcnt(0)
    ds_read_b64_tr_b16 v[192:193], v3 offset:32768
    ds_read_b64_tr_b16 v[194:195], v3 offset:33280
    ds_read_b64_tr_b16 v[196:197], v3 offset:36864
    ds_read_b64_tr_b16 v[198:199], v3 offset:37376
    ds_read_b64_tr_b16 v[200:201], v3 offset:40960
    ds_read_b64_tr_b16 v[202:203], v3 offset:41472
    ds_read_b64_tr_b16 v[204:205], v3 offset:45056
    ds_read_b64_tr_b16 v[206:207], v3 offset:45568
    s_waitcnt lgkmcnt(0)
    ds_read_b64_tr_b16 v[208:209], v3 offset:49152
    ds_read_b64_tr_b16 v[210:211], v3 offset:49664
    ds_read_b64_tr_b16 v[212:213], v3 offset:53248
    ds_read_b64_tr_b16 v[214:215], v3 offset:53760
    ds_read_b64_tr_b16 v[216:217], v3 offset:57344
    ds_read_b64_tr_b16 v[218:219], v3 offset:57856
    ds_read_b64_tr_b16 v[220:221], v3 offset:61440
    ds_read_b64_tr_b16 v[222:223], v3 offset:61952
    s_waitcnt lgkmcnt(0)
L_F_NOW1:
    s_mul_i32 s58, s3, 8448
    s_add_u32 s58, s58, 22528
    v_add_u32 v45, s58, v45
    v_lshlrev_b32 v40, 16, v40
    v_lshlrev_b32 v41, 16, v41
    v_lshlrev_b32 v42, 16, v42
    v_lshlrev_b32 v43, 16, v43
    s_waitcnt vmcnt(7)
    ds_write_b128 v45, v[64:67] offset:0
    s_waitcnt vmcnt(6)
    ds_write_b128 v45, v[68:71] offset:1056
    s_waitcnt vmcnt(5)
    ds_write_b128 v45, v[72:75] offset:2112
    s_waitcnt vmcnt(4)
    ds_write_b128 v45, v[76:79] offset:3168
    s_waitcnt vmcnt(3)
    ds_write_b128 v45, v[80:83] offset:4224
    s_waitcnt vmcnt(2)
    ds_write_b128 v45, v[84:87] offset:5280
    s_waitcnt vmcnt(1)
    ds_write_b128 v45, v[88:91] offset:6336
    s_waitcnt vmcnt(0)
    ds_write_b128 v45, v[92:95] offset:7392
    s_waitcnt lgkmcnt(0)
    s_barrier
    v_lshrrev_b32 v3, 4, v0
    v_bfe_u32 v4, v0, 2, 2
    v_lshl_add_u32 v3, v3, 3, v4
    s_movk_i32 s56, 1056
    v_mul_lo_u32 v3, v3, s56
    v_and_b32 v4, 3, v0
    v_lshl_add_u32 v3, v4, 3, v3
    s_lshl_b32 s56, s3, 7
    s_add_u32 s56, s56, 22528
    v_add_u32 v3, s56, v3
    ds_read_b64_tr_b16 v[64:65], v3 offset:0
    ds_read_b64_tr_b16 v[66:67], v3 offset:4224
    ds_read_b64_tr_b16 v[68:69], v3 offset:33792
    ds_read_b64_tr_b16 v[70:71], v3 offset:38016
    ds_read_b64_tr_b16 v[72:73], v3 offset:32
    ds_read_b64_tr_b16 v[74:75], v3 offset:4256
    ds_read_b64_tr_b16 v[76:77], v3 offset:33824
    ds_read_b64_tr_b16 v[78:79], v3 offset:38048
    s_waitcnt lgkmcnt(0)
    ds_read_b64_tr_b16 v[80:81], v3 offset:64
    ds_read_b64_tr_b16 v[82:83], v3 offset:4288
    ds_read_b64_tr_b16 v[84:85], v3 offset:33856
    ds_read_b64_tr_b16 v[86:87], v3 offset:38080
    ds_read_b64_tr_b16 v[88:89], v3 offset:96
    ds_read_b64_tr_b16 v[90:91], v3 offset:4320
    ds_read_b64_tr_b16 v[92:93], v3 offset:33888
    ds_read_b64_tr_b16 v[94:95], v3 offset:38112
    s_waitcnt lgkmcnt(0)
    s_lshl_b32 s56, s52, 2
    s_and_b32 s57, s53, 3
    s_add_u32 s56, s56, s57
    s_lshl_b32 s56, s56, 7
    s_add_u32 s56, s56, 0xc000
    v_and_b32 v12, 7, v0
    v_lshlrev_b32 v12, 4, v12
L_GT_28:
    buffer_load_dwordx4 v[8:11], v12, s[32:35], s56 offen sc1
    s_waitcnt vmcnt(0)
    v_cmpx_eq_u32 vcc, s30, v9
    v_cmpx_eq_u32 vcc, s30, v11
    s_cmp_eq_u64 exec, -1
    s_mov_b64 exec, -1
    s_cbranch_scc1 L_GTOK_29
    s_sleep 8
    s_add_u32 s31, s31, 1
    s_cmp_lt_u32 s31, 100000
    s_cbranch_scc1 L_GT_28
    s_branch L_BAIL
L_GTOK_29:
    v_lshrrev_b32 v46, 3, v0
    s_movk_i32 s56, 4096
    v_mul_lo_u32 v46, v46, s56
    v_and_b32 v4, 7, v0
    v_lshl_add_u32 v46, v4, 4, v46
    s_lshl_b32 s62, s3, 15
    s_lshl_b32 s57, s54, 7
    s_add_u32 s62, s62, s57
    s_add_u32 s62, s62, 0x340000
    s_lshl_b32 s56, s3, 9
    s_lshl_b32 s57, s52, 15
    s_add_u32 s56, s56, s57
    s_add_u32 s56, s56, 0x240000
    s_add_u32 s57, s56, 4096
    s_add_u32 s58, s56, 8192
    s_add_u32 s59, s56, 12288
    v_lshlrev_b32 v3, 3, v0
    v_add_u32 v4, 0x4000, v3
    v_and_b32 v5, 15, v0
    v_min_u32 v5, 4, v5
    s_movk_i32 s60, 1040
    v_mul_lo_u32 v5, v5, s60
    v_lshrrev_b32 v6, 4, v0
    v_lshl_add_u32 v5, v6, 4, v5
    v_add_u32 v5, 0, v5
    v_and_b32 v7, 3, v0
    s_movk_i32 s60, 144
    v_mul_lo_u32 v2, v7, s60
    v_lshl_add_u32 v7, v6, 3, v2
    s_lshl_b32 s60, s3, 5
    v_add_u32 v7, s60, v7
    v_lshl_add_u32 v2, v6, 4, v2
    s_lshl_b32 s60, s3, 12
    s_add_u32 s60, s60, s56
L_R2_30:
    buffer_load_dwordx2 v[10:11], v3, s[32:35], s56 offen sc1
    buffer_load_dwordx2 v[14:15], v3, s[32:35], s57 offen sc1
    buffer_load_dwordx2 v[18:19], v3, s[32:35], s58 offen sc1
    buffer_load_dwordx2 v[22:23], v3, s[32:35], s59 offen sc1
    buffer_load_dwordx2 v[26:27], v4, s[32:35], s56 offen sc1
    buffer_load_dwordx2 v[30:31], v4, s[32:35], s57 offen sc1
    buffer_load_dwordx2 v[34:35], v4, s[32:35], s58 offen sc1
    buffer_load_dwordx2 v[38:39], v4, s[32:35], s59 offen sc1
    s_waitcnt vmcnt(0)
    v_cmpx_ne_u32 vcc, -1, v10
    v_cmpx_ne_u32 vcc, -1, v11
    v_cmpx_ne_u32 vcc, -1, v14
    v_cmpx_ne_u32 vcc, -1, v15
    v_cmpx_ne_u32 vcc, -1, v18
    v_cmpx_ne_u32 vcc, -1, v19
    v_cmpx_ne_u32 vcc, -1, v22
    v_cmpx_ne_u32 vcc, -1, v23
    v_cmpx_ne_u32 vcc, -1, v26
    v_cmpx_ne_u32 vcc, -1, v27
    v_cmpx_ne_u32 vcc, -1, v30
    v_cmpx_ne_u32 vcc, -1, v31
    v_cmpx_ne_u32 vcc, -1, v34
    v_cmpx_ne_u32 vcc, -1, v35
    v_cmpx_ne_u32 vcc, -1, v38
    v_cmpx_ne_u32 vcc, -1, v39
    s_cmp_eq_u64 exec, -1
    s_mov_b64 exec, -1
    s_cbranch_scc1 L_R2OK_31
    s_add_u32 s31, s31, 1
    s_cmp_lt_u32 s31, 100000
    s_cbranch_scc1 L_R2_30
    s_branch L_BAIL
L_R2OK_31:
    v_lshlrev_b32 v8, 16, v10
    v_and_b32 v9, 0xffff0000, v10
    v_lshlrev_b32 v10, 16, v11
    v_and_b32 v11, 0xffff0000, v11
    v_lshlrev_b32 v12, 16, v14
    v_and_b32 v13, 0xffff0000, v14
    v_lshlrev_b32 v14, 16, v15
    v_and_b32 v15, 0xffff0000, v15
    v_lshlrev_b32 v16, 16, v18
    v_and_b32 v17, 0xffff0000, v18
    v_lshlrev_b32 v18, 16, v19
    v_and_b32 v19, 0xffff0000, v19
    v_lshlrev_b32 v20, 16, v22
    v_and_b32 v21, 0xffff0000, v22
    v_lshlrev_b32 v22, 16, v23
    v_and_b32 v23, 0xffff0000, v23
    v_lshlrev_b32 v24, 16, v26
    v_and_b32 v25, 0xffff0000, v26
    v_lshlrev_b32 v26, 16, v27
    v_and_b32 v27, 0xffff0000, v27
    v_lshlrev_b32 v28, 16, v30
    v_and_b32 v29, 0xffff0000, v30
    v_lshlrev_b32 v30, 16, v31
    v_and_b32 v31, 0xffff0000, v31
    v_lshlrev_b32 v32, 16, v34
    v_and_b32 v33, 0xffff0000, v34
    v_lshlrev_b32 v34, 16, v35
    v_and_b32 v35, 0xffff0000, v35
    v_lshlrev_b32 v36, 16, v38
    v_and_b32 v37, 0xffff0000, v38
    v_lshlrev_b32 v38, 16, v39
    v_and_b32 v39, 0xffff0000, v39
    v_pk_add_f32 v[8:9], v[8:9], v[12:13]
    v_pk_add_f32 v[10:11], v[10:11], v[14:15]
    v_pk_add_f32 v[16:17], v[16:17], v[20:21]
    v_pk_add_f32 v[18:19], v[18:19], v[22:23]
    v_pk_add_f32 v[24:25], v[24:25], v[28:29]
    v_pk_add_f32 v[26:27], v[26:27], v[30:31]
    v_pk_add_f32 v[32:33], v[32:33], v[36:37]
    v_pk_add_f32 v[34:35], v[34:35], v[38:39]
    v_pk_add_f32 v[8:9], v[8:9], v[16:17]
    v_pk_add_f32 v[10:11], v[10:11], v[18:19]
    v_pk_add_f32 v[24:25], v[24:25], v[32:33]
    v_pk_add_f32 v[26:27], v[26:27], v[34:35]
    v_pk_add_f32 v[24:25], v[8:9], v[24:25]
    v_pk_add_f32 v[26:27], v[10:11], v[26:27]
    v_cvt_pk_bf16_f32 v28, v24, v25
    v_cvt_pk_bf16_f32 v29, v26, v27
    v_lshlrev_b32 v24, 16, v28
    v_and_b32 v25, 0xffff0000, v28
    v_lshlrev_b32 v26, 16, v29
    v_and_b32 v27, 0xffff0000, v29
    v_add_f32 v24, v24, v40
    v_add_f32 v25, v25, v41
    v_add_f32 v26, v26, v42
    v_add_f32 v27, v27, v43
    v_cvt_pk_bf16_f32 v28, v24, v25
    v_cvt_pk_bf16_f32 v29, v26, v27
    ds_write_b16 v44, v28
    ds_write_b16_d16_hi v44, v28 offset:1040
    ds_write_b16 v44, v29 offset:2080
    ds_write_b16_d16_hi v44, v29 offset:3120
    s_waitcnt lgkmcnt(0)
    s_barrier
    s_cmp_ge_u32 s3, 4
    s_cbranch_scc1 L_F_GRAM
    ds_read_b128 v[16:19], v5 offset:0
    ds_read_b128 v[20:23], v5 offset:64
    ds_read_b128 v[24:27], v5 offset:128
    ds_read_b128 v[28:31], v5 offset:192
    s_waitcnt lgkmcnt(3)
    v_mfma_f32_16x16x32_bf16 v[32:35], v[96:99], v[16:19], 0
    v_mfma_f32_16x16x32_bf16 v[36:39], v[160:163], v[16:19], 0
    ds_read_b128 v[16:19], v5 offset:256
    s_waitcnt lgkmcnt(3)
    v_mfma_f32_16x16x32_bf16 v[32:35], v[100:103], v[20:23], v[32:35]
    v_mfma_f32_16x16x32_bf16 v[36:39], v[164:167], v[20:23], v[36:39]
    ds_read_b128 v[20:23], v5 offset:320
    s_waitcnt lgkmcnt(3)
    v_mfma_f32_16x16x32_bf16 v[32:35], v[104:107], v[24:27], v[32:35]
    v_mfma_f32_16x16x32_bf16 v[36:39], v[168:171], v[24:27], v[36:39]
    ds_read_b128 v[24:27], v5 offset:384
    s_waitcnt lgkmcnt(3)
    v_mfma_f32_16x16x32_bf16 v[32:35], v[108:111], v[28:31], v[32:35]
    v_mfma_f32_16x16x32_bf16 v[36:39], v[172:175], v[28:31], v[36:39]
    ds_read_b128 v[28:31], v5 offset:448
    s_waitcnt lgkmcnt(3)
    v_mfma_f32_16x16x32_bf16 v[32:35], v[112:115], v[16:19], v[32:35]
    v_mfma_f32_16x16x32_bf16 v[36:39], v[176:179], v[16:19], v[36:39]
    ds_read_b128 v[16:19], v5 offset:512
    s_waitcnt lgkmcnt(3)
    v_mfma_f32_16x16x32_bf16 v[32:35], v[116:119], v[20:23], v[32:35]
    v_mfma_f32_16x16x32_bf16 v[36:39], v[180:183], v[20:23], v[36:39]
    ds_read_b128 v[20:23], v5 offset:576
    s_waitcnt lgkmcnt(3)
    v_mfma_f32_16x16x32_bf16 v[32:35], v[120:123], v[24:27], v[32:35]
    v_mfma_f32_16x16x32_bf16 v[36:39], v[184:187], v[24:27], v[36:39]
    ds_read_b128 v[24:27], v5 offset:640
    s_waitcnt lgkmcnt(3)
    v_mfma_f32_16x16x32_bf16 v[32:35], v[124:127], v[28:31], v[32:35]
    v_mfma_f32_16x16x32_bf16 v[36:39], v[188:191], v[28:31], v[36:39]
    ds_read_b128 v[28:31], v5 offset:704
    s_barrier
    s_waitcnt lgkmcnt(3)
    v_mfma_f32_16x16x32_bf16 v[32:35], v[128:131], v[16:19], v[32:35]
    v_mfma_f32_16x16x32_bf16 v[36:39], v[192:195], v[16:19], v[36:39]
    ds_read_b128 v[16:19], v5 offset:768
    s_waitcnt lgkmcnt(3)
    v_mfma_f32_16x16x32_bf16 v[32:35], v[132:135], v[20:23], v[32:35]
    v_mfma_f32_16x16x32_bf16 v[36:39], v[196:199], v[20:23], v[36:39]
    ds_read_b128 v[20:23], v5 offset:832
    s_waitcnt lgkmcnt(3)
    v_mfma_f32_16x16x32_bf16 v[32:35], v[136:139], v[24:27], v[32:35]
    v_mfma_f32_16x16x32_bf16 v[36:39], v[200:203], v[24:27], v[36:39]
    ds_read_b128 v[24:27], v5 offset:896
    s_waitcnt lgkmcnt(3)
    v_mfma_f32_16x16x32_bf16 v[32:35], v[140:143], v[28:31], v[32:35]
    v_mfma_f32_16x16x32_bf16 v[36:39], v[204:207], v[28:31], v[36:39]
    ds_read_b128 v[28:31], v5 offset:960
    s_waitcnt lgkmcnt(3)
    v_mfma_f32_16x16x32_bf16 v[32:35], v[144:147], v[16:19], v[32:35]
    v_mfma_f32_16x16x32_bf16 v[36:39], v[208:211], v[16:19], v[36:39]
    s_waitcnt lgkmcnt(2)
    v_mfma_f32_16x16x32_bf16 v[32:35], v[148:151], v[20:23], v[32:35]
    v_mfma_f32_16x16x32_bf16 v[36:39], v[212:215], v[20:23], v[36:39]
    s_waitcnt lgkmcnt(1)
    v_mfma_f32_16x16x32_bf16 v[32:35], v[152:155], v[24:27], v[32:35]
    v_mfma_f32_16x16x32_bf16 v[36:39], v[216:219], v[24:27], v[36:39]
    s_waitcnt lgkmcnt(0)
    v_mfma_f32_16x16x32_bf16 v[32:35], v[156:159], v[28:31], v[32:35]
    v_mfma_f32_16x16x32_bf16 v[36:39], v[220:223], v[28:31], v[36:39]
    v_and_b32 v12, 3, v0
    v_lshlrev_b32 v12, 4, v12
    s_barrier
    ds_read_b128 v[16:19], v12 offset:10752
    s_mov_b32 s60, 0xbfb8aa3b
    s_mov_b32 s61, s60
    s_nop 2
    v_mov_b32_dpp v24, v32 row_newbcast:4 row_mask:0xf bank_mask:0xf
    v_mov_b32_dpp v25, v33 row_newbcast:4 row_mask:0xf bank_mask:0xf
    v_mov_b32_dpp v26, v34 row_newbcast:4 row_mask:0xf bank_mask:0xf
    v_mov_b32_dpp v27, v35 row_newbcast:4 row_mask:0xf bank_mask:0xf
    v_mov_b32_dpp v28, v36 row_newbcast:4 row_mask:0xf bank_mask:0xf
    v_mov_b32_dpp v29, v37 row_newbcast:4 row_mask:0xf bank_mask:0xf
    v_mov_b32_dpp v30, v38 row_newbcast:4 row_mask:0xf bank_mask:0xf
    v_mov_b32_dpp v31, v39 row_newbcast:4 row_mask:0xf bank_mask:0xf
    s_waitcnt lgkmcnt(0)
    v_pk_fma_f32 v[32:33], v[16:17], v[24:25], v[32:33]
    v_pk_fma_f32 v[34:35], v[16:17], v[26:27], v[34:35]
    v_pk_fma_f32 v[36:37], v[16:17], v[28:29], v[36:37]
    v_pk_fma_f32 v[38:39], v[16:17], v[30:31], v[38:39]
    v_pk_mul_f32 v[32:33], v[32:33], v[18:19]
    v_pk_mul_f32 v[34:35], v[34:35], v[18:19]
    v_pk_mul_f32 v[36:37], v[36:37], v[18:19]
    v_pk_mul_f32 v[38:39], v[38:39], v[18:19]
    v_pk_mul_f32 v[24:25], v[32:33], s[60:61]
    v_pk_mul_f32 v[26:27], v[34:35], s[60:61]
    v_exp_f32 v24, v24
    v_exp_f32 v25, v25
    v_exp_f32 v26, v26
    v_exp_f32 v27, v27
    v_pk_mul_f32 v[32:33], v[32:33], v[36:37]
    v_pk_mul_f32 v[34:35], v[34:35], v[38:39]
    v_pk_add_f32 v[24:25], v[24:25], 1.0 op_sel_hi:[1,0]
    v_pk_add_f32 v[26:27], v[26:27], 1.0 op_sel_hi:[1,0]
    v_rcp_f32 v24, v24
    v_rcp_f32 v25, v25
    v_rcp_f32 v26, v26
    v_rcp_f32 v27, v27
    s_mov_b32 exec_lo, 0x000f000f
    s_mov_b32 exec_hi, 0x000f000f
    v_pk_mul_f32 v[24:25], v[24:25], v[32:33]
    v_pk_mul_f32 v[26:27], v[26:27], v[34:35]
    v_cvt_pk_bf16_f32 v24, v24, v25
    v_cvt_pk_bf16_f32 v25, v26, v27
    ds_write_b64 v7, v[24:25] offset:9216
    s_mov_b64 exec, -1
    s_waitcnt lgkmcnt(0)
    s_branch L_F_G2
L_F_GRAM:
    s_sub_u32 s60, s3, 4
    s_lshl_b32 s61, s60, 8
    v_add_u32 v5, s61, v5
    ds_read_b128 v[16:19], v5 offset:0
    ds_read_b128 v[20:23], v5 offset:64
    ds_read_b128 v[24:27], v5 offset:128
    ds_read_b128 v[28:31], v5 offset:192
    v_and_b32 v12, 3, v0
    v_mul_u32_u24 v13, 20, v12
    v_lshlrev_b32 v12, 4, v12
    v_lshl_add_u32 v14, v6, 6, v12
    s_lshl_b32 s61, s60, 7
    v_add_u32 v14, s61, v14
    s_waitcnt lgkmcnt(3)
    v_mfma_f32_16x16x32_bf16 v[32:35], v[16:19], v[16:19], 0
    s_waitcnt lgkmcnt(2)
    v_mfma_f32_16x16x32_bf16 v[32:35], v[20:23], v[20:23], v[32:35]
    s_waitcnt lgkmcnt(1)
    v_mfma_f32_16x16x32_bf16 v[32:35], v[24:27], v[24:27], v[32:35]
    s_waitcnt lgkmcnt(0)
    v_mfma_f32_16x16x32_bf16 v[32:35], v[28:31], v[28:31], v[32:35]
    s_nop 7
    s_mov_b32 exec_lo, 0x000f000f
    s_mov_b32 exec_hi, 0
    ds_write_b128 v14, v[32:35] offset:10240
    s_mov_b64 exec, -1
    s_waitcnt lgkmcnt(0)
    s_barrier
    s_cmp_lg_u32 s3, 4
    s_cbranch_scc1 L_F_NOST
    ds_read_b32 v16, v13 offset:10240
    ds_read_b32 v20, v12 offset:10304
    ds_read_b32 v17, v13 offset:10368
    ds_read_b32 v21, v12 offset:10432
    ds_read_b32 v18, v13 offset:10496
    ds_read_b32 v22, v12 offset:10560
    ds_read_b32 v19, v13 offset:10624
    ds_read_b32 v23, v12 offset:10688
    s_waitcnt lgkmcnt(0)
    v_add_f32 v16, v16, v17
    v_add_f32 v18, v18, v19
    v_add_f32 v20, v20, v21
    v_add_f32 v22, v22, v23
    v_add_f32 v16, v16, v18
    v_add_f32 v20, v20, v22
    v_mul_f32 v20, 0x3b000000, v20
    v_mul_f32 v16, 0x3b000000, v16
    v_fma_f32 v16, -v20, v20, v16
    v_max_f32 v16, 0, v16
    v_cvt_pk_bf16_f32 v20, v20, v20
    v_and_b32 v20, 0xffff0000, v20
    v_cvt_pk_bf16_f32 v16, v16, v16
    v_and_b32 v16, 0xffff0000, v16
    v_add_f32 v16, 0x3727c5ac, v16
    v_cvt_pk_bf16_f32 v16, v16, v16
    v_and_b32 v16, 0xffff0000, v16
    v_sqrt_f32 v16, v16
    v_sub_f32 v24, 0, v20
    v_cvt_pk_bf16_f32 v16, v16, v16
    v_and_b32 v16, 0xffff0000, v16
    v_rcp_f32 v26, v16
    v_mov_b32 v25, v24
    v_mov_b32 v27, v26
    s_mov_b64 exec, 15
    ds_write_b128 v12, v[24:27] offset:10752
    s_mov_b64 exec, -1
    s_waitcnt lgkmcnt(0)
L_F_NOST:
    s_barrier
L_F_G2:
    v_mov_b32 v9, s30
    v_mov_b32 v11, s30
    s_barrier
    ds_read_b128 v[16:19], v2 offset:9216
    ds_read_b128 v[20:23], v2 offset:9280
    s_waitcnt lgkmcnt(1)
    v_mfma_f32_16x16x32_bf16 v[24:27], v[16:19], v[64:67], 0
    v_mfma_f32_16x16x32_bf16 v[28:31], v[16:19], v[72:75], 0
    v_mfma_f32_16x16x32_bf16 v[32:35], v[16:19], v[80:83], 0
    v_mfma_f32_16x16x32_bf16 v[36:39], v[16:19], v[88:91], 0
    s_waitcnt lgkmcnt(0)
    v_mfma_f32_16x16x32_bf16 v[24:27], v[20:23], v[68:71], v[24:27]
    v_mfma_f32_16x16x32_bf16 v[28:31], v[20:23], v[76:79], v[28:31]
    v_mfma_f32_16x16x32_bf16 v[32:35], v[20:23], v[84:87], v[32:35]
    v_mfma_f32_16x16x32_bf16 v[36:39], v[20:23], v[92:95], v[36:39]
    s_nop 4
    v_cvt_pk_bf16_f32 v8, v24, v25
    v_cvt_pk_bf16_f32 v10, v26, v27
    s_mov_b32 exec_lo, 0xffff0000
    v_cvt_pk_bf16_f32 v8, v28, v29
    v_cvt_pk_bf16_f32 v10, v30, v31
    s_mov_b32 exec_lo, 0
    v_cvt_pk_bf16_f32 v8, v32, v33
    v_cvt_pk_bf16_f32 v10, v34, v35
    s_mov_b32 exec_hi, 0xffff0000
    s_nop 0
    v_cvt_pk_bf16_f32 v8, v36, v37
    v_cvt_pk_bf16_f32 v10, v38, v39
    s_mov_b64 exec, -1
    buffer_store_dwordx4 v[8:11], v46, s[32:35], s62 offen sc1
    s_branch L_FIN
L_BAIL:
L_FIN:
L_END:
    s_endpgm
L_CODE_END:
    .section .rodata,"a"
    .p2align 6
    .amdhsa_kernel sequential_preLN__compressed_kv_cla__swiglu_ffn__decode_kernel
    .amdhsa_next_free_vgpr 256
    .amdhsa_next_free_sgpr 102
    .amdhsa_accum_offset 256
    .amdhsa_group_segment_fixed_size 0
    .amdhsa_kernarg_size 104
    .amdhsa_user_sgpr_count 2
    .amdhsa_user_sgpr_kernarg_segment_ptr 1
    .amdhsa_system_sgpr_workgroup_id_x 1
    .amdhsa_float_denorm_mode_32 3
    .end_amdhsa_kernel
```
